```python
import torch

def _softmax(x, axis=-1):
    return torch.softmax(x, dim=axis)
def _gelu(x):
    return torch.nn.functional.gelu(x, approximate="tanh")
def _silu(x):
    return torch.nn.functional.silu(x)
def _sigmoid(x):
    return torch.sigmoid(x)
def _layernorm(x, axis=-1, eps=1e-5):
    m = x.mean(dim=axis, keepdim=True)
    v = x.var(dim=axis, keepdim=True, unbiased=False)
    return (x - m) / torch.sqrt(v + eps)
def _scatter_add(tgt, idx, src, axis=0):
    return tgt.clone().index_add_(axis, idx, src)
def _segment_sum(src, seg, n):
    out = torch.zeros((n,) + src.shape[1:], dtype=src.dtype)
    return out.index_add_(0, seg, src)
def _pad(x, pw):
    flat = tuple(v for pair in reversed(pw) for v in pair)
    return torch.nn.functional.pad(x, flat)

kernel_name = 'sequential_preLN__grouped_kv_mqa__glu_gated_reglu__prompt'

def setup_inputs():

    _w = (lambda a: (lambda t: t.to(torch.bfloat16) if t.is_floating_point() else t)(torch.as_tensor(a)))
    def _A_setup():
        B, S, D, H = 1, 2048, 512, 32
        Dh = D // H
        return {
            "x": _w((lambda *s: torch.randn(*s, dtype=torch.bfloat16) * 0.05)(B, S, D)),
            "wq": _w((lambda *s: torch.randn(*s, dtype=torch.bfloat16) * 0.05)(D, H * Dh)),
            "wk": _w((lambda *s: torch.randn(*s, dtype=torch.bfloat16) * 0.05)(D, Dh)),
            "wv": _w((lambda *s: torch.randn(*s, dtype=torch.bfloat16) * 0.05)(D, Dh)),
            "wo": _w((lambda *s: torch.randn(*s, dtype=torch.bfloat16) * 0.05)(H * Dh, D)),
        }
    _A_in = _A_setup()

    def _B_setup():
        B, S, D, F = 1, 2048, 512, 1792
        return {
            "x": _w((lambda *s: torch.randn(*s, dtype=torch.bfloat16) * 0.05)(B, S, D)),
            "W_gate": _w((lambda *s: torch.randn(*s, dtype=torch.bfloat16) * 0.4)(D, F) * (2.0 / D) ** 0.5),
            "W_up": _w((lambda *s: torch.randn(*s, dtype=torch.bfloat16) * 0.4)(D, F) * (2.0 / D) ** 0.5),
            "W_down": _w((lambda *s: torch.randn(*s, dtype=torch.bfloat16) * 0.4)(F, D) * (1.0 / F) ** 0.5),
        }
    _B_in = _B_setup()

    return {
        "A_x": _A_in["x"],
        "A_wq": _A_in["wq"],
        "A_wk": _A_in["wk"],
        "A_wv": _A_in["wv"],
        "A_wo": _A_in["wo"],
        "B_x": _B_in["x"],
        "B_W_gate": _B_in["W_gate"],
        "B_W_up": _B_in["W_up"],
        "B_W_down": _B_in["W_down"],
    }

def reference(A_x, A_wq, A_wk, A_wv, A_wo, B_x, B_W_gate, B_W_up, B_W_down):
    def _A_ref(x, wq, wk, wv, wo):
        B, S, D = x.shape
        H = 32
        Dh = D // H
        q = (lambda x, *d: x.permute(*d))((x @ wq).reshape(B, S, H, Dh), 0, 2, 1, 3)
        k = x @ wk
        v = x @ wv
        scores = torch.einsum("bhqd,bkd->bhqk", q, k) * (Dh ** -0.5)
        p = _softmax(scores, axis=-1)
        o = torch.einsum("bhqk,bkd->bhqd", p, v)
        return (lambda x, *d: x.permute(*d))(o, 0, 2, 1, 3).reshape(B, S, H * Dh) @ wo

    def _B_ref(x, W_gate, W_up, W_down):
        gate = torch.einsum("bsd,df->bsf", x, W_gate)
        up = torch.einsum("bsd,df->bsf", x, W_up)
        gate = gate * (lambda x, dt: x.to(dt))(gate > 0, gate.dtype)
        h = gate * up
        return torch.einsum("bsf,fd->bsd", h, W_down)

    x = A_x
    h = x + _A_ref(_layernorm(x, axis=-1), A_wq, A_wk, A_wv, A_wo)
    h2 = h + _B_ref(_layernorm(h, axis=-1), B_W_gate, B_W_up, B_W_down)
    return h2
```

```asm
; @launch grid=(256,1,1) block=(512,1,1) lds=163840
.amdgcn_target "amdgcn-amd-amdhsa--gfx950"
.text
.globl sequential_preLN__grouped_kv_mqa__glu_gated_reglu__prompt_kernel
.p2align 8
.type sequential_preLN__grouped_kv_mqa__glu_gated_reglu__prompt_kernel,@function
sequential_preLN__grouped_kv_mqa__glu_gated_reglu__prompt_kernel:
    s_cmp_ge_u32 s2, 256
    s_cbranch_scc1 L_exit_mk
    s_load_dwordx2 s[4:5], s[0:1], 88
    s_load_dwordx2 s[6:7], s[0:1], 0
    s_load_dwordx2 s[58:59], s[0:1], 8
    s_load_dwordx4 s[52:55], s[0:1], 16
    s_load_dwordx2 s[60:61], s[0:1], 80
    s_load_dwordx2 s[32:33], s[0:1], 32
    s_load_dwordx4 s[36:39], s[0:1], 48
    s_load_dwordx4 s[40:43], s[0:1], 64
    v_lshrrev_b32 v2, 6, v0
    v_and_b32 v1, 63, v0
    s_nop 0
    v_readfirstlane_b32 s16, v2
    s_nop 3
    s_getpc_b64 s[28:29]
L_pc_1:
    s_lshr_b32 s30, s2, 3
    s_lshl_b32 s30, s30, 3
    s_add_u32 s30, s30, s16
    s_mul_hi_u32 s31, s30, 130150525
    s_mul_i32 s31, s31, 33
    s_sub_u32 s30, s30, s31
    s_lshl_b32 s30, s30, 10
    s_add_u32 s28, s28, s30
    s_addc_u32 s29, s29, 0
    v_lshlrev_b32 v133, 4, v1
    global_load_dwordx4 v[128:131], v133, s[28:29]
    s_and_b32 s17, s2, 7
    s_lshr_b32 s18, s2, 3
    s_and_b32 s19, s18, 3
    s_lshl_b32 s17, s17, 2
    s_add_u32 s17, s17, s19
    s_lshr_b32 s18, s18, 2
    s_lshl_b32 s19, s17, 3
    s_add_u32 s19, s19, s18
    v_and_b32 v6, 15, v1
    v_lshrrev_b32 v7, 4, v1
    v_lshrrev_b32 v8, 3, v1
    v_and_b32 v9, 7, v1
    v_xor_b32 v10, v9, v7
    v_xor_b32 v11, 4, v10
    v_lshlrev_b32 v12, 10, v8
    v_lshl_add_u32 v2, v10, 4, v12
    v_lshl_add_u32 v127, v11, 4, v12
    v_lshlrev_b32 v5, 4, v1
    s_lshr_b32 s21, s16, 1
    s_and_b32 s22, s16, 1
    s_lshl_b32 s22, s22, 2
    s_lshl_b32 s23, s17, 2
    s_add_u32 s23, s23, s21
    s_lshl_b32 s23, s23, 14
    s_lshl_b32 s44, s22, 7
    s_add_u32 s44, s44, s23
    s_lshl_b32 s45, s21, 14
    s_lshl_b32 s23, s22, 11
    s_add_u32 s45, s45, s23
    s_and_b32 s21, s16, 3
    s_lshr_b32 s22, s16, 2
    s_lshl_b32 s22, s22, 3
    s_add_u32 s21, s21, s22
    s_lshl_b32 s56, s21, 15
    s_lshl_b32 s22, s18, 7
    s_add_u32 s56, s56, s22
    s_lshl_b32 s57, s21, 12
    s_add_u32 s57, s57, 65536
    s_waitcnt lgkmcnt(0)
    s_mov_b32 s8, s4
    s_and_b32 s9, s5, 0xffff
    s_mov_b32 s10, 33554432
    s_mov_b32 s11, 0x00020000
    s_mov_b32 s12, s6
    s_and_b32 s13, s7, 0xffff
    s_mov_b32 s14, 2097152
    s_mov_b32 s15, 0x00020000
    s_mov_b32 s20, s58
    s_and_b32 s21, s59, 0xffff
    s_mov_b32 s22, 524288
    s_mov_b32 s23, 0x00020000
    s_and_b32 s28, s18, 1
    s_cmp_eq_u32 s28, 0
    s_cselect_b32 s28, s52, s54
    s_cselect_b32 s29, s53, s55
    s_mov_b32 s24, s28
    s_and_b32 s25, s29, 0xffff
    s_mov_b32 s26, 16384
    s_mov_b32 s27, 0x00020000
    s_mov_b32 s48, s60
    s_and_b32 s49, s61, 0xffff
    s_mov_b32 s50, 256
    s_mov_b32 s51, 0x00020000
    s_or_b32 s28, s2, s16
    s_cmp_lg_u32 s28, 0
    s_cbranch_scc1 L_nn_2
    s_memrealtime s[28:29]
    s_waitcnt lgkmcnt(0)
    s_lshl_b32 s28, s28, 1
    s_or_b32 s28, s28, 1
    s_bitset0_b32 s28, 31
    v_mov_b32 v14, s28
    v_mov_b32 v15, 0
    s_mov_b64 exec, 1
    buffer_store_dword v14, v15, s[48:51], 0 offen sc1
    s_mov_b64 exec, -1
L_nn_2:
    s_lshl_b32 s28, s16, 11
    s_add_u32 s29, s28, 131072
    s_mov_b32 m0, s29
    s_add_u32 s29, s29, 1024
    buffer_load_dwordx4 v5, s[24:27], s28 offen lds
    s_add_u32 s28, s28, 1024
    s_mov_b32 m0, s29
    s_add_u32 s29, s29, 1024
    buffer_load_dwordx4 v5, s[24:27], s28 offen lds
    s_add_u32 s28, s28, 1024
    s_mov_b32 m0, s45
    s_add_u32 s45, s45, 1024
    buffer_load_dwordx4 v2, s[12:15], s44 offen lds
    s_mov_b32 m0, s45
    s_add_u32 s45, s45, 1024
    s_add_u32 s28, s44, 8192
    buffer_load_dwordx4 v127, s[12:15], s28 offen lds
    s_add_u32 s44, s44, 128
    s_mov_b32 m0, s45
    s_add_u32 s45, s45, 1024
    buffer_load_dwordx4 v2, s[12:15], s44 offen lds
    s_mov_b32 m0, s45
    s_add_u32 s45, s45, 1024
    s_add_u32 s28, s44, 8192
    buffer_load_dwordx4 v127, s[12:15], s28 offen lds
    s_add_u32 s44, s44, 128
    s_mov_b32 m0, s45
    s_add_u32 s45, s45, 1024
    buffer_load_dwordx4 v2, s[12:15], s44 offen lds
    s_mov_b32 m0, s45
    s_add_u32 s45, s45, 1024
    s_add_u32 s28, s44, 8192
    buffer_load_dwordx4 v127, s[12:15], s28 offen lds
    s_add_u32 s44, s44, 128
    s_mov_b32 m0, s45
    s_add_u32 s45, s45, 1024
    buffer_load_dwordx4 v2, s[12:15], s44 offen lds
    s_mov_b32 m0, s45
    s_add_u32 s45, s45, 1024
    s_add_u32 s28, s44, 8192
    buffer_load_dwordx4 v127, s[12:15], s28 offen lds
    s_add_u32 s44, s44, 128
    v_and_b32 v62, 7, v1
    v_lshrrev_b32 v60, 1, v62
    v_bfe_u32 v61, v1, 4, 1
    v_xor_b32 v60, v60, v61
    v_xor_b32 v61, 2, v60
    v_and_b32 v62, 1, v62
    v_lshl_or_b32 v60, v60, 1, v62
    v_lshl_or_b32 v61, v61, 1, v62
    v_lshrrev_b32 v62, 3, v1
    v_lshlrev_b32 v62, 10, v62
    v_lshl_add_u32 v124, v60, 4, v62
    v_lshl_add_u32 v127, v61, 4, v62
    s_and_b32 s30, s16, 3
    s_lshr_b32 s31, s16, 2
    v_lshrrev_b32 v8, 2, v6
    v_and_b32 v9, 3, v1
    v_lshrrev_b32 v10, 1, v8
    v_and_b32 v11, 1, v7
    v_lshl_or_b32 v10, v11, 1, v10
    v_xor_b32 v10, s30, v10
    v_lshl_add_u32 v11, v7, 3, v8
    v_lshlrev_b32 v16, 7, v11
    v_lshl_add_u32 v16, v10, 5, v16
    v_lshl_add_u32 v16, v9, 3, v16
    s_lshl_b32 s28, s31, 15
    s_add_u32 s28, s28, 65536
    v_add_u32 v12, s28, v16
    v_lshlrev_b32 v16, 5, v11
    v_lshl_add_u32 v16, v9, 3, v16
    s_lshl_b32 s28, s31, 13
    s_add_u32 s28, s28, 131072
    v_add_u32 v4, s28, v16
    v_lshrrev_b32 v16, 1, v6
    v_xor_b32 v16, v16, v7
    v_lshlrev_b32 v16, 4, v16
    v_lshl_add_u32 v16, v6, 7, v16
    s_lshl_b32 s28, s31, 13
    v_add_u32 v13, s28, v16
    v_xor_b32 v14, 64, v13
    s_lshl_b32 s29, s30, 14
    v_add_u32 v15, s29, v13
    v_add_u32 v3, s29, v14
    v_mov_b32 v88, 0
    v_mov_b32 v89, 0
    v_mov_b32 v90, 0
    v_mov_b32 v91, 0
    v_mov_b32 v92, 0
    v_mov_b32 v93, 0
    v_mov_b32 v94, 0
    v_mov_b32 v95, 0
    v_mov_b32 v96, 0
    v_mov_b32 v97, 0
    v_mov_b32 v98, 0
    v_mov_b32 v99, 0
    v_mov_b32 v100, 0
    v_mov_b32 v101, 0
    v_mov_b32 v102, 0
    v_mov_b32 v103, 0
    v_mov_b32 v104, 0
    v_mov_b32 v105, 0
    v_mov_b32 v106, 0
    v_mov_b32 v107, 0
    v_mov_b32 v108, 0
    v_mov_b32 v109, 0
    v_mov_b32 v110, 0
    v_mov_b32 v111, 0
    v_mov_b32 v112, 0
    v_mov_b32 v113, 0
    v_mov_b32 v114, 0
    v_mov_b32 v115, 0
    v_mov_b32 v116, 0
    v_mov_b32 v117, 0
    v_mov_b32 v118, 0
    v_mov_b32 v119, 0
    v_mov_b32 v120, 0
    v_mov_b32 v121, 0
    v_mov_b32 v122, 0
    v_mov_b32 v123, 0
    v_mov_b32 v24, 0x3f803f80
    v_mov_b32 v25, 0x3f803f80
    v_mov_b32 v26, 0x3f803f80
    v_mov_b32 v27, 0x3f803f80
    s_waitcnt vmcnt(0)
    s_barrier
    ds_read_b128 v[48:51], v15 offset:0
    ds_read_b64_tr_b16 v[28:29], v4 offset:0
    ds_read_b64_tr_b16 v[30:31], v4 offset:128
    ds_read_b128 v[52:55], v3 offset:0
    ds_read_b64_tr_b16 v[32:33], v4 offset:1024
    ds_read_b64_tr_b16 v[34:35], v4 offset:1152
    ds_read_b128 v[56:59], v15 offset:2048
    ds_read_b64_tr_b16 v[36:37], v4 offset:2048
    ds_read_b64_tr_b16 v[38:39], v4 offset:2176
    ds_read_b128 v[60:63], v3 offset:2048
    ds_read_b64_tr_b16 v[40:41], v4 offset:3072
    ds_read_b64_tr_b16 v[42:43], v4 offset:3200
    ds_read_b128 v[64:67], v15 offset:4096
    ds_read_b64_tr_b16 v[80:81], v4 offset:4096
    ds_read_b64_tr_b16 v[82:83], v4 offset:4224
    s_waitcnt lgkmcnt(12)
    v_mfma_f32_16x16x32_bf16 v[116:119], v[28:31], v[48:51], v[116:119]
    v_mfma_f32_16x16x32_bf16 v[108:111], v[24:27], v[48:51], v[108:111]
    v_mfma_f32_16x16x32_bf16 v[112:115], v[48:51], v[48:51], v[112:115]
    v_mfma_f32_16x16x32_bf16 v[120:123], v[28:31], v[24:27], v[120:123]
    s_mov_b32 m0, s57
    s_add_u32 s57, s57, 1024
    buffer_load_dwordx4 v124, s[20:23], s56 offen lds
    s_add_u32 s56, s56, 8192
    ds_read_b128 v[68:71], v3 offset:4096
    ds_read_b64_tr_b16 v[84:85], v4 offset:5120
    ds_read_b64_tr_b16 v[86:87], v4 offset:5248
    s_waitcnt lgkmcnt(12)
    v_mfma_f32_16x16x32_bf16 v[116:119], v[32:35], v[52:55], v[116:119]
    v_mfma_f32_16x16x32_bf16 v[108:111], v[24:27], v[52:55], v[108:111]
    v_mfma_f32_16x16x32_bf16 v[112:115], v[52:55], v[52:55], v[112:115]
    v_mfma_f32_16x16x32_bf16 v[120:123], v[32:35], v[24:27], v[120:123]
    s_mov_b32 m0, s57
    s_add_u32 s57, s57, 1024
    buffer_load_dwordx4 v127, s[20:23], s56 offen lds
    s_add_u32 s56, s56, 8192
    ds_read_b128 v[72:75], v15 offset:6144
    ds_read_b64_tr_b16 v[16:17], v4 offset:6144
    ds_read_b64_tr_b16 v[18:19], v4 offset:6272
    s_waitcnt lgkmcnt(12)
    v_mfma_f32_16x16x32_bf16 v[116:119], v[36:39], v[56:59], v[116:119]
    v_mfma_f32_16x16x32_bf16 v[108:111], v[24:27], v[56:59], v[108:111]
    v_mfma_f32_16x16x32_bf16 v[112:115], v[56:59], v[56:59], v[112:115]
    v_mfma_f32_16x16x32_bf16 v[120:123], v[36:39], v[24:27], v[120:123]
    s_mov_b32 m0, s57
    s_add_u32 s57, s57, 1024
    buffer_load_dwordx4 v124, s[20:23], s56 offen lds
    s_add_u32 s56, s56, 8192
    ds_read_b128 v[76:79], v3 offset:6144
    ds_read_b64_tr_b16 v[20:21], v4 offset:7168
    ds_read_b64_tr_b16 v[22:23], v4 offset:7296
    s_waitcnt lgkmcnt(12)
    v_mfma_f32_16x16x32_bf16 v[116:119], v[40:43], v[60:63], v[116:119]
    v_mfma_f32_16x16x32_bf16 v[108:111], v[24:27], v[60:63], v[108:111]
    v_mfma_f32_16x16x32_bf16 v[112:115], v[60:63], v[60:63], v[112:115]
    v_mfma_f32_16x16x32_bf16 v[120:123], v[40:43], v[24:27], v[120:123]
    s_mov_b32 m0, s57
    s_add_u32 s57, s57, 1024
    buffer_load_dwordx4 v127, s[20:23], s56 offen lds
    s_add_u32 s56, s56, 8192
    s_add_u32 s56, s56, 98304
    s_add_u32 s57, s57, 12288
    s_waitcnt lgkmcnt(9)
    v_mfma_f32_16x16x32_bf16 v[116:119], v[80:83], v[64:67], v[116:119]
    v_mfma_f32_16x16x32_bf16 v[108:111], v[24:27], v[64:67], v[108:111]
    v_mfma_f32_16x16x32_bf16 v[112:115], v[64:67], v[64:67], v[112:115]
    v_mfma_f32_16x16x32_bf16 v[120:123], v[80:83], v[24:27], v[120:123]
    s_mov_b32 m0, s57
    s_add_u32 s57, s57, 1024
    buffer_load_dwordx4 v124, s[20:23], s56 offen lds
    s_add_u32 s56, s56, 8192
    s_waitcnt lgkmcnt(6)
    v_mfma_f32_16x16x32_bf16 v[116:119], v[84:87], v[68:71], v[116:119]
    v_mfma_f32_16x16x32_bf16 v[108:111], v[24:27], v[68:71], v[108:111]
    v_mfma_f32_16x16x32_bf16 v[112:115], v[68:71], v[68:71], v[112:115]
    v_mfma_f32_16x16x32_bf16 v[120:123], v[84:87], v[24:27], v[120:123]
    s_mov_b32 m0, s57
    s_add_u32 s57, s57, 1024
    buffer_load_dwordx4 v127, s[20:23], s56 offen lds
    s_add_u32 s56, s56, 8192
    s_waitcnt lgkmcnt(3)
    v_mfma_f32_16x16x32_bf16 v[116:119], v[16:19], v[72:75], v[116:119]
    v_mfma_f32_16x16x32_bf16 v[108:111], v[24:27], v[72:75], v[108:111]
    v_mfma_f32_16x16x32_bf16 v[112:115], v[72:75], v[72:75], v[112:115]
    v_mfma_f32_16x16x32_bf16 v[120:123], v[16:19], v[24:27], v[120:123]
    s_mov_b32 m0, s57
    s_add_u32 s57, s57, 1024
    buffer_load_dwordx4 v124, s[20:23], s56 offen lds
    s_add_u32 s56, s56, 8192
    s_waitcnt lgkmcnt(0)
    v_mfma_f32_16x16x32_bf16 v[116:119], v[20:23], v[76:79], v[116:119]
    v_mfma_f32_16x16x32_bf16 v[108:111], v[24:27], v[76:79], v[108:111]
    v_mfma_f32_16x16x32_bf16 v[112:115], v[76:79], v[76:79], v[112:115]
    v_mfma_f32_16x16x32_bf16 v[120:123], v[20:23], v[24:27], v[120:123]
    s_mov_b32 m0, s57
    s_add_u32 s57, s57, 1024
    buffer_load_dwordx4 v127, s[20:23], s56 offen lds
    s_add_u32 s56, s56, 8192
    v_and_b32 v8, 3, v6
    v_lshrrev_b32 v9, 2, v6
    s_nop 5
    v_cmp_eq_u32 vcc, 1, v8
    s_nop 1
    v_cndmask_b32 v112, v112, v113, vcc
    v_cmp_eq_u32 vcc, 2, v8
    s_nop 1
    v_cndmask_b32 v112, v112, v114, vcc
    v_cmp_eq_u32 vcc, 3, v8
    s_nop 1
    v_cndmask_b32 v112, v112, v115, vcc
    v_cmp_eq_u32 vcc, v9, v7
    s_nop 1
    v_cndmask_b32 v109, 0, v112, vcc
    v_mov_b32 v16, v109
    s_nop 1
    v_permlane32_swap_b32 v109, v16
    s_nop 0
    v_add_f32 v109, v109, v16
    v_mov_b32 v16, v109
    s_nop 1
    v_permlane16_swap_b32 v109, v16
    s_nop 0
    v_add_f32 v109, v109, v16
    s_lshl_b32 s28, s16, 10
    s_add_u32 s28, s28, 147456
    v_add_u32 v9, s28, v5
    ds_write_b128 v9, v[116:119]
    s_lshl_b32 s28, s16, 6
    s_add_u32 s28, s28, 155648
    v_lshlrev_b32 v11, 4, v7
    v_add_u32 v9, s28, v11
    s_lshl_b32 s28, s30, 1
    s_add_u32 s28, s28, s31
    s_lshl_b32 s29, s28, 7
    s_add_u32 s29, s29, 156160
    v_lshlrev_b32 v10, 3, v6
    v_add_u32 v10, s29, v10
    s_mov_b32 exec_lo, 0x00010001
    s_mov_b32 exec_hi, 0x00010001
    ds_write_b128 v9, v[120:123]
    s_mov_b64 exec, 0xffff
    ds_write_b64 v10, v[108:109]
    s_mov_b64 exec, -1
    v_mov_b32 v16, 157216
    v_mov_b32 v17, 0
    s_mov_b64 exec, 1
    ds_write_b32 v16, v17
    s_mov_b64 exec, -1
    s_waitcnt lgkmcnt(0)
    s_barrier
    v_mov_b32 v15, 0
    buffer_load_dword v125, v15, s[48:51], 0 offen sc1
    s_mov_b32 s44, 989855744
    s_mov_b32 s45, 925353388
    s_mov_b32 s46, 1052289595
    v_lshrrev_b32 v126, 1, v7
    v_lshlrev_b32 v126, 5, v126
    v_add_u32 v126, v126, v6
    v_lshlrev_b32 v126, 4, v126
    v_and_b32 v17, 1, v7
    v_lshl_add_u32 v126, v17, 3, v126
    s_waitcnt vmcnt(1)
    s_barrier
    s_cmp_ge_u32 s18, 2
    s_cbranch_scc1 L_notprod_4
    s_cmp_lg_u32 s31, 0
    s_cbranch_scc1 L_nokv_3
    s_lshl_b32 s28, s30, 10
    s_add_u32 s28, s28, 147456
    v_add_u32 v9, s28, v5
    ds_read_b128 v[40:43], v9
    ds_read_b128 v[44:47], v9 offset:4096
    s_lshl_b32 s28, s30, 6
    s_add_u32 s28, s28, 155648
    v_add_u32 v9, s28, v11
    ds_read_b128 v[48:51], v9
    ds_read_b128 v[52:55], v9 offset:256
    s_lshl_b32 s29, s30, 8
    s_add_u32 s29, s29, 156160
    v_lshlrev_b32 v10, 3, v6
    v_add_u32 v10, s29, v10
    ds_read_b64 v[56:57], v10
    ds_read_b64 v[58:59], v10 offset:128
    s_waitcnt lgkmcnt(0)
    v_add_f32 v40, v40, v44
    v_add_f32 v48, v48, v52
    v_add_f32 v41, v41, v45
    v_add_f32 v49, v49, v53
    v_add_f32 v42, v42, v46
    v_add_f32 v50, v50, v54
    v_add_f32 v43, v43, v47
    v_add_f32 v51, v51, v55
    v_add_f32 v56, v56, v58
    v_add_f32 v57, v57, v59
    v_mul_f32 v72, s44, v56
    v_mul_f32 v57, s44, v57
    v_fma_f32 v57, -v72, v72, v57
    v_max_f32 v57, 0, v57
    v_add_f32 v57, s45, v57
    v_rsq_f32 v74, v57
    s_nop 0
    v_fma_f32 v40, -v72, v48, v40
    v_mul_f32 v40, v40, v74
    v_fma_f32 v41, -v72, v49, v41
    v_mul_f32 v41, v41, v74
    v_fma_f32 v42, -v72, v50, v42
    v_mul_f32 v42, v42, v74
    v_fma_f32 v43, -v72, v51, v43
    v_mul_f32 v43, v43, v74
    v_cvt_pk_bf16_f32 v76, v40, v41
    v_cvt_pk_bf16_f32 v77, v42, v43
    s_lshl_b32 s47, s17, 2
    s_add_u32 s47, s47, s30
    s_lshr_b32 s28, s47, 1
    s_mul_i32 s28, s28, 2112
    s_add_u32 s28, s28, 6291456
    s_and_b32 s29, s47, 1
    s_cmp_eq_u32 s18, 1
    s_cbranch_scc1 L_isv_5
    s_lshl_b32 s29, s29, 8
    s_add_u32 s28, s28, s29
    buffer_store_dwordx2 v[76:77], v126, s[8:11], s28 offen sc1
    s_branch L_mx_6
L_isv_5:
    s_mul_i32 s29, s29, 544
    s_add_u32 s28, s28, s29
    s_add_u32 s28, s28, 1024
    v_bfe_u32 v44, v6, 2, 1
    v_lshlrev_b32 v44, 8, v44
    v_lshl_add_u32 v44, v7, 6, v44
    v_and_b32 v45, 3, v6
    v_lshrrev_b32 v46, 3, v6
    v_lshl_add_u32 v45, v46, 2, v45
    v_lshl_add_u32 v44, v45, 1, v44
    s_lshl_b32 s29, s16, 10
    s_add_u32 s29, s29, 131072
    v_add_u32 v44, s29, v44
    ds_write_b16 v44, v76
    ds_write_b16_d16_hi v44, v76 offset:16
    ds_write_b16 v44, v77 offset:32
    ds_write_b16_d16_hi v44, v77 offset:48
    v_cmp_eq_u32 vcc, 32, v1
    v_mov_b32 v52, 0x3f803f80
    s_nop 0
    v_cndmask_b32 v48, 0, v52, vcc
    v_cndmask_b32 v49, 0, v52, vcc
    v_cndmask_b32 v50, 0, v52, vcc
    v_cndmask_b32 v51, 0, v52, vcc
    v_add_u32 v45, s29, v5
    s_waitcnt lgkmcnt(0)
    s_mov_b32 exec_lo, -1
    s_mov_b32 exec_hi, 0
    ds_read_b128 v[48:51], v45
    s_waitcnt lgkmcnt(0)
    s_mov_b32 exec_lo, -1
    s_mov_b32 exec_hi, 3
    buffer_store_dwordx4 v[48:51], v5, s[8:11], s28 offen sc1
    s_mov_b64 exec, -1
L_mx_6:
    v_mov_b32 v44, 0
    v_dot2_f32_bf16 v44, v76, v76, v44
    v_dot2_f32_bf16 v44, v77, v77, v44
    s_nop 2
    v_mov_b32 v45, v44
    s_nop 1
    v_permlane32_swap_b32 v44, v45
    s_nop 0
    v_add_f32 v44, v44, v45
    v_mov_b32 v45, v44
    s_nop 1
    v_permlane16_swap_b32 v44, v45
    s_nop 0
    v_add_f32 v44, v44, v45
    s_nop 1
    v_max_f32_dpp v44, v44, v44 row_ror:8 row_mask:0xf bank_mask:0xf
    s_nop 1
    v_max_f32_dpp v44, v44, v44 row_ror:4 row_mask:0xf bank_mask:0xf
    s_nop 1
    v_max_f32_dpp v44, v44, v44 row_ror:2 row_mask:0xf bank_mask:0xf
    s_nop 1
    v_max_f32_dpp v44, v44, v44 row_ror:1 row_mask:0xf bank_mask:0xf
    s_lshl_b32 s29, s30, 2
    s_add_u32 s29, s29, 157184
    v_mov_b32 v45, s29
    s_mov_b64 exec, 1
    ds_write_b32 v45, v44
    s_mov_b64 exec, -1
L_nokv_3:
L_notprod_4:
    v_lshlrev_b32 v2, 4, v1
    ds_read_b64_tr_b16 v[40:41], v12 offset:0
    ds_read_b64_tr_b16 v[42:43], v12 offset:512
    ds_read_b128 v[48:51], v13 offset:0
    ds_read_b128 v[52:55], v13 offset:16384
    ds_read_b128 v[56:59], v13 offset:32768
    ds_read_b128 v[60:63], v13 offset:49152
    ds_read_b64_tr_b16 v[44:45], v12 offset:4096
    ds_read_b64_tr_b16 v[46:47], v12 offset:4608
    ds_read_b128 v[68:71], v14 offset:0
    ds_read_b128 v[72:75], v14 offset:16384
    ds_read_b128 v[76:79], v14 offset:32768
    ds_read_b128 v[80:83], v14 offset:49152
    s_waitcnt lgkmcnt(6)
    v_mfma_f32_16x16x32_bf16 v[88:91], v[40:43], v[48:51], v[88:91]
    v_mfma_f32_16x16x32_bf16 v[92:95], v[40:43], v[52:55], v[92:95]
    v_mfma_f32_16x16x32_bf16 v[96:99], v[40:43], v[56:59], v[96:99]
    v_mfma_f32_16x16x32_bf16 v[100:103], v[40:43], v[60:63], v[100:103]
    v_mfma_f32_16x16x32_bf16 v[104:107], v[40:43], v[24:27], v[104:107]
    ds_read_b64_tr_b16 v[40:41], v12 offset:8192
    ds_read_b64_tr_b16 v[42:43], v12 offset:8704
    ds_read_b128 v[48:51], v13 offset:2048
    ds_read_b128 v[52:55], v13 offset:18432
    ds_read_b128 v[56:59], v13 offset:34816
    ds_read_b128 v[60:63], v13 offset:51200
    s_waitcnt lgkmcnt(6)
    v_mfma_f32_16x16x32_bf16 v[88:91], v[44:47], v[68:71], v[88:91]
    v_mfma_f32_16x16x32_bf16 v[92:95], v[44:47], v[72:75], v[92:95]
    v_mfma_f32_16x16x32_bf16 v[96:99], v[44:47], v[76:79], v[96:99]
    v_mfma_f32_16x16x32_bf16 v[100:103], v[44:47], v[80:83], v[100:103]
    v_mfma_f32_16x16x32_bf16 v[104:107], v[44:47], v[24:27], v[104:107]
    ds_read_b64_tr_b16 v[44:45], v12 offset:12288
    ds_read_b64_tr_b16 v[46:47], v12 offset:12800
    ds_read_b128 v[68:71], v14 offset:2048
    ds_read_b128 v[72:75], v14 offset:18432
    ds_read_b128 v[76:79], v14 offset:34816
    ds_read_b128 v[80:83], v14 offset:51200
    s_waitcnt lgkmcnt(6)
    v_mfma_f32_16x16x32_bf16 v[88:91], v[40:43], v[48:51], v[88:91]
    v_mfma_f32_16x16x32_bf16 v[92:95], v[40:43], v[52:55], v[92:95]
    v_mfma_f32_16x16x32_bf16 v[96:99], v[40:43], v[56:59], v[96:99]
    v_mfma_f32_16x16x32_bf16 v[100:103], v[40:43], v[60:63], v[100:103]
    v_mfma_f32_16x16x32_bf16 v[104:107], v[40:43], v[24:27], v[104:107]
    ds_read_b64_tr_b16 v[40:41], v12 offset:16384
    ds_read_b64_tr_b16 v[42:43], v12 offset:16896
    ds_read_b128 v[48:51], v13 offset:4096
    ds_read_b128 v[52:55], v13 offset:20480
    ds_read_b128 v[56:59], v13 offset:36864
    ds_read_b128 v[60:63], v13 offset:53248
    s_waitcnt lgkmcnt(6)
    v_mfma_f32_16x16x32_bf16 v[88:91], v[44:47], v[68:71], v[88:91]
    v_mfma_f32_16x16x32_bf16 v[92:95], v[44:47], v[72:75], v[92:95]
    v_mfma_f32_16x16x32_bf16 v[96:99], v[44:47], v[76:79], v[96:99]
    v_mfma_f32_16x16x32_bf16 v[100:103], v[44:47], v[80:83], v[100:103]
    v_mfma_f32_16x16x32_bf16 v[104:107], v[44:47], v[24:27], v[104:107]
    s_cmp_ge_u32 s18, 2
    s_cbranch_scc1 L_npl_7
    s_cmp_ge_u32 s16, 4
    s_cbranch_scc1 L_npl_7
    s_waitcnt vmcnt(0)
    s_mov_b32 s28, 0
L_nz_8:
    v_readfirstlane_b32 s62, v125
    s_add_u32 s28, s28, 1
    s_cmp_lg_u32 s62, 0
    s_cbranch_scc1 L_nok_9
    s_cmp_gt_u32 s28, 200000
    s_cbranch_scc1 L_nok_9
    v_mov_b32 v15, 0
    buffer_load_dword v125, v15, s[48:51], 0 offen sc1
    s_waitcnt vmcnt(0)
    s_branch L_nz_8
L_nok_9:
    v_mov_b32 v16, 157216
    v_mov_b32 v17, 1
    s_mov_b64 exec, 1
    ds_add_rtn_u32 v19, v16, v17
    s_mov_b64 exec, -1
    s_waitcnt lgkmcnt(0)
    v_readfirstlane_b32 s29, v19
    s_nop 3
    s_cmp_lg_u32 s29, 3
    s_cbranch_scc1 L_npl_7
    s_lshl_b32 s29, s17, 1
    s_add_u32 s29, s29, s18
    s_lshl_b32 s29, s29, 7
    s_add_u32 s29, s29, 25395200
    v_mov_b32 v18, 157184
    ds_read_b128 v[20:23], v18
    v_mov_b32 v16, s62
    v_mov_b32 v18, 0
    s_waitcnt lgkmcnt(0)
    v_max3_f32 v17, v20, v21, v22
    v_max_f32 v17, v17, v23
    s_mov_b64 exec, 1
    buffer_store_dwordx2 v[16:17], v18, s[8:11], s29 offen sc1
    s_mov_b64 exec, -1
L_nkvf_10:
L_npl_7:
    ds_read_b64_tr_b16 v[44:45], v12 offset:20480
    ds_read_b64_tr_b16 v[46:47], v12 offset:20992
    ds_read_b128 v[68:71], v14 offset:4096
    ds_read_b128 v[72:75], v14 offset:20480
    ds_read_b128 v[76:79], v14 offset:36864
    ds_read_b128 v[80:83], v14 offset:53248
    s_waitcnt lgkmcnt(6)
    v_mfma_f32_16x16x32_bf16 v[88:91], v[40:43], v[48:51], v[88:91]
    v_mfma_f32_16x16x32_bf16 v[92:95], v[40:43], v[52:55], v[92:95]
    v_mfma_f32_16x16x32_bf16 v[96:99], v[40:43], v[56:59], v[96:99]
    v_mfma_f32_16x16x32_bf16 v[100:103], v[40:43], v[60:63], v[100:103]
    v_mfma_f32_16x16x32_bf16 v[104:107], v[40:43], v[24:27], v[104:107]
    ds_read_b64_tr_b16 v[40:41], v12 offset:24576
    ds_read_b64_tr_b16 v[42:43], v12 offset:25088
    ds_read_b128 v[48:51], v13 offset:6144
    ds_read_b128 v[52:55], v13 offset:22528
    ds_read_b128 v[56:59], v13 offset:38912
    ds_read_b128 v[60:63], v13 offset:55296
    s_waitcnt lgkmcnt(6)
    v_mfma_f32_16x16x32_bf16 v[88:91], v[44:47], v[68:71], v[88:91]
    v_mfma_f32_16x16x32_bf16 v[92:95], v[44:47], v[72:75], v[92:95]
    v_mfma_f32_16x16x32_bf16 v[96:99], v[44:47], v[76:79], v[96:99]
    v_mfma_f32_16x16x32_bf16 v[100:103], v[44:47], v[80:83], v[100:103]
    v_mfma_f32_16x16x32_bf16 v[104:107], v[44:47], v[24:27], v[104:107]
    ds_read_b64_tr_b16 v[44:45], v12 offset:28672
    ds_read_b64_tr_b16 v[46:47], v12 offset:29184
    ds_read_b128 v[68:71], v14 offset:6144
    ds_read_b128 v[72:75], v14 offset:22528
    ds_read_b128 v[76:79], v14 offset:38912
    ds_read_b128 v[80:83], v14 offset:55296
    s_waitcnt lgkmcnt(6)
    v_mfma_f32_16x16x32_bf16 v[88:91], v[40:43], v[48:51], v[88:91]
    v_mfma_f32_16x16x32_bf16 v[92:95], v[40:43], v[52:55], v[92:95]
    v_mfma_f32_16x16x32_bf16 v[96:99], v[40:43], v[56:59], v[96:99]
    v_mfma_f32_16x16x32_bf16 v[100:103], v[40:43], v[60:63], v[100:103]
    v_mfma_f32_16x16x32_bf16 v[104:107], v[40:43], v[24:27], v[104:107]
    s_waitcnt lgkmcnt(0)
    v_mfma_f32_16x16x32_bf16 v[88:91], v[44:47], v[68:71], v[88:91]
    v_mfma_f32_16x16x32_bf16 v[92:95], v[44:47], v[72:75], v[92:95]
    v_mfma_f32_16x16x32_bf16 v[96:99], v[44:47], v[76:79], v[96:99]
    v_mfma_f32_16x16x32_bf16 v[100:103], v[44:47], v[80:83], v[100:103]
    v_mfma_f32_16x16x32_bf16 v[104:107], v[44:47], v[24:27], v[104:107]
    s_barrier
    s_cmp_lg_u32 s16, 5
    s_cbranch_scc1 L_wt_11
    v_lshlrev_b32 v134, 21, v1
    s_mov_b64 exec, 0xffff
    buffer_load_dword v132, v134, s[8:11], 0 offen
    s_mov_b64 exec, -1
L_wt_11:
    s_lshl_b32 s28, s30, 13
    s_lshl_b32 s29, s31, 12
    s_add_u32 s28, s28, s29
    s_add_u32 s28, s28, 16384
    v_add_u32 v9, s28, v5
    ds_write_b128 v9, v[88:91] offset:0
    ds_write_b128 v9, v[92:95] offset:1024
    ds_write_b128 v9, v[96:99] offset:2048
    ds_write_b128 v9, v[100:103] offset:3072
    s_lshl_b32 s28, s16, 10
    v_add_u32 v9, s28, v5
    ds_write_b128 v9, v[104:107] offset:49152
    s_waitcnt lgkmcnt(0)
    s_barrier
    s_lshl_b32 s28, s30, 13
    s_lshl_b32 s29, s31, 11
    s_add_u32 s28, s28, s29
    s_add_u32 s28, s28, 16384
    v_add_u32 v9, s28, v5
    ds_read_b128 v[40:43], v9 offset:0
    ds_read_b128 v[44:47], v9 offset:4096
    ds_read_b128 v[48:51], v9 offset:1024
    ds_read_b128 v[52:55], v9 offset:5120
    s_lshl_b32 s29, s31, 9
    s_add_u32 s29, s29, 156160
    v_lshlrev_b32 v10, 3, v6
    v_add_u32 v10, s29, v10
    ds_read_b64 v[56:57], v10 offset:0
    ds_read_b64 v[58:59], v10 offset:128
    ds_read_b64 v[60:61], v10 offset:256
    ds_read_b64 v[62:63], v10 offset:384
    s_lshl_b32 s29, s30, 10
    v_add_u32 v11, s29, v5
    ds_read_b128 v[64:67], v11 offset:49152
    ds_read_b128 v[68:71], v11 offset:53248
    s_lshl_b32 s28, s16, 10
    s_add_u32 s28, s28, 57344
    v_add_u32 v17, s28, v126
    s_waitcnt lgkmcnt(0)
    v_add_f32 v64, v64, v68
    v_add_f32 v65, v65, v69
    v_add_f32 v66, v66, v70
    v_add_f32 v67, v67, v71
    v_add_f32 v56, v56, v58
    v_add_f32 v57, v57, v59
    v_mul_f32 v72, s44, v56
    v_mul_f32 v57, s44, v57
    v_fma_f32 v57, -v72, v72, v57
    v_max_f32 v57, 0, v57
    v_add_f32 v57, s45, v57
    v_rsq_f32 v74, v57
    v_add_f32 v60, v60, v62
    v_add_f32 v61, v61, v63
    v_mul_f32 v73, s44, v60
    v_mul_f32 v61, s44, v61
    v_fma_f32 v61, -v73, v73, v61
    v_max_f32 v61, 0, v61
    v_add_f32 v61, s45, v61
    v_rsq_f32 v75, v61
    s_nop 0
    v_mul_f32 v74, s46, v74
    v_add_f32 v40, v40, v44
    v_fma_f32 v40, -v72, v64, v40
    v_mul_f32 v40, v40, v74
    v_add_f32 v41, v41, v45
    v_fma_f32 v41, -v72, v65, v41
    v_mul_f32 v41, v41, v74
    v_add_f32 v42, v42, v46
    v_fma_f32 v42, -v72, v66, v42
    v_mul_f32 v42, v42, v74
    v_add_f32 v43, v43, v47
    v_fma_f32 v43, -v72, v67, v43
    v_mul_f32 v43, v43, v74
    v_cvt_pk_bf16_f32 v76, v40, v41
    v_cvt_pk_bf16_f32 v77, v42, v43
    ds_write_b64 v17, v[76:77] offset:0
    v_mul_f32 v75, s46, v75
    v_add_f32 v48, v48, v52
    v_fma_f32 v48, -v73, v64, v48
    v_mul_f32 v48, v48, v75
    v_add_f32 v49, v49, v53
    v_fma_f32 v49, -v73, v65, v49
    v_mul_f32 v49, v49, v75
    v_add_f32 v50, v50, v54
    v_fma_f32 v50, -v73, v66, v50
    v_mul_f32 v50, v50, v75
    v_add_f32 v51, v51, v55
    v_fma_f32 v51, -v73, v67, v51
    v_mul_f32 v51, v51, v75
    v_cvt_pk_bf16_f32 v78, v48, v49
    v_cvt_pk_bf16_f32 v79, v50, v51
    ds_write_b64 v17, v[78:79] offset:256
    s_cmp_lg_u32 s16, 7
    s_cbranch_scc1 L_we_12
    v_lshlrev_b32 v121, 7, v1
    s_mov_b32 s21, 25395200
    buffer_load_dwordx2 v[122:123], v121, s[8:11], s21 offen sc1
L_we_12:
    v_mov_b32 v40, 0
    v_mov_b32 v41, 0
    v_dot2_f32_bf16 v40, v76, v76, v40
    v_dot2_f32_bf16 v40, v77, v77, v40
    v_dot2_f32_bf16 v41, v78, v78, v41
    v_dot2_f32_bf16 v41, v79, v79, v41
    s_nop 2
    v_mov_b32 v42, v40
    v_mov_b32 v43, v41
    s_nop 1
    v_permlane32_swap_b32 v40, v42
    v_permlane32_swap_b32 v41, v43
    s_nop 1
    v_add_f32 v40, v40, v42
    v_add_f32 v41, v41, v43
    s_nop 0
    v_mov_b32 v42, v40
    v_mov_b32 v43, v41
    s_nop 1
    v_permlane16_swap_b32 v40, v42
    v_permlane16_swap_b32 v41, v43
    s_nop 1
    v_add_f32 v40, v40, v42
    v_add_f32 v41, v41, v43
    v_mov_b32 v44, 0x7f800000
    v_add_f32 v42, v40, v41
    v_max_f32 v40, v40, v41
    v_cmp_u_f32 vcc, v42, v42
    s_nop 1
    v_cndmask_b32 v40, v40, v44, vcc
    s_nop 1
    v_max_f32_dpp v40, v40, v40 row_ror:8 row_mask:0xf bank_mask:0xf
    s_nop 1
    v_max_f32_dpp v40, v40, v40 row_ror:4 row_mask:0xf bank_mask:0xf
    s_nop 1
    v_max_f32_dpp v40, v40, v40 row_ror:2 row_mask:0xf bank_mask:0xf
    s_nop 1
    v_max_f32_dpp v40, v40, v40 row_ror:1 row_mask:0xf bank_mask:0xf
    s_lshl_b32 s28, s16, 2
    s_add_u32 s28, s28, 157440
    v_mov_b32 v41, s28
    s_mov_b64 exec, 1
    ds_write_b32 v41, v40
    s_mov_b64 exec, -1
    s_waitcnt vmcnt(0)
    s_mov_b32 s28, 0
L_nz_13:
    v_readfirstlane_b32 s62, v125
    s_add_u32 s28, s28, 1
    s_cmp_lg_u32 s62, 0
    s_cbranch_scc1 L_nok_14
    s_cmp_gt_u32 s28, 200000
    s_cbranch_scc1 L_nok_14
    v_mov_b32 v15, 0
    buffer_load_dword v125, v15, s[48:51], 0 offen sc1
    s_waitcnt vmcnt(0)
    s_branch L_nz_13
L_nok_14:
    s_cmp_lg_u32 s16, 7
    s_cbranch_scc1 L_kvw_15
    s_mov_b32 s22, 0
    s_branch L_kvf_18
L_kvp_16:
    v_lshlrev_b32 v121, 7, v1
    s_mov_b32 s21, 25395200
    buffer_load_dwordx2 v[122:123], v121, s[8:11], s21 offen sc1
L_kvf_18:
    s_add_u32 s22, s22, 1
    s_waitcnt vmcnt(0)
    v_cmp_ne_u32 vcc, s62, v122
    s_cmp_gt_u32 s22, 200000
    s_cbranch_scc1 L_kvd_17
    s_cbranch_vccz L_kvd_17
    s_sleep 2
    s_branch L_kvp_16
L_kvd_17:
    v_mov_b32 v44, 0x7f800000
    v_cmp_u_f32 vcc, v123, v123
    s_nop 1
    v_cndmask_b32 v123, v123, v44, vcc
    v_and_b32 v45, 1, v1
    v_cmp_eq_u32 vcc, 0, v45
    s_nop 1
    v_cndmask_b32 v46, 0, v123, vcc
    v_cmp_eq_u32 vcc, 1, v45
    s_nop 1
    v_cndmask_b32 v47, 0, v123, vcc
    s_nop 1
    v_max_f32_dpp v46, v46, v46 row_ror:8 row_mask:0xf bank_mask:0xf
    v_max_f32_dpp v47, v47, v47 row_ror:8 row_mask:0xf bank_mask:0xf
    s_nop 1
    v_max_f32_dpp v46, v46, v46 row_ror:4 row_mask:0xf bank_mask:0xf
    v_max_f32_dpp v47, v47, v47 row_ror:4 row_mask:0xf bank_mask:0xf
    s_nop 1
    v_max_f32_dpp v46, v46, v46 row_ror:2 row_mask:0xf bank_mask:0xf
    v_max_f32_dpp v47, v47, v47 row_ror:2 row_mask:0xf bank_mask:0xf
    s_nop 1
    v_max_f32_dpp v46, v46, v46 row_ror:1 row_mask:0xf bank_mask:0xf
    v_max_f32_dpp v47, v47, v47 row_ror:1 row_mask:0xf bank_mask:0xf
    v_mov_b32 v48, v46
    v_mov_b32 v49, v47
    s_nop 1
    v_permlane32_swap_b32 v46, v48
    v_permlane32_swap_b32 v47, v49
    s_nop 1
    v_max_f32 v46, v46, v48
    v_max_f32 v47, v47, v49
    s_nop 0
    v_mov_b32 v48, v46
    v_mov_b32 v49, v47
    s_nop 1
    v_permlane16_swap_b32 v46, v48
    v_permlane16_swap_b32 v47, v49
    s_nop 1
    v_max_f32 v46, v46, v48
    v_max_f32 v47, v47, v49
    v_mov_b32 v41, 157472
    s_mov_b64 exec, 1
    ds_write_b64 v41, v[46:47]
    s_mov_b64 exec, -1
L_kvw_15:
    s_barrier
    s_add_u32 s12, s4, 6291456
    s_addc_u32 s13, s5, 0
    s_and_b32 s13, s13, 0xffff
    s_mov_b32 s14, 135168
    s_mov_b32 s15, 0x00020000
    s_and_b32 s63, s16, 3
    s_lshr_b32 s21, s16, 2
    s_lshl_b32 s21, s21, 4
    s_add_u32 s63, s63, s21
    s_lshl_b32 s63, s63, 12
    s_mov_b32 m0, s63
    s_nop 0
    buffer_load_dwordx4 v2, s[12:15], s63 offen offset:0 sc1 lds
    buffer_load_dwordx4 v2, s[12:15], s63 offen offset:1024 sc1 lds
    buffer_load_dwordx4 v2, s[12:15], s63 offen offset:2048 sc1 lds
    buffer_load_dwordx4 v2, s[12:15], s63 offen offset:3072 sc1 lds
    s_lshl_b32 s20, s17, 6
    s_lshl_b32 s21, s18, 2
    s_add_u32 s20, s20, s21
    s_and_b32 s21, s16, 3
    s_add_u32 s20, s20, s21
    s_lshl_b32 s20, s20, 10
    s_add_u32 s20, s20, 2097152
    s_lshr_b32 s44, s2, 1
    s_and_b32 s45, s2, 1
    s_sub_u32 s46, 4, s45
    s_lshl_b32 s56, s16, 12
    s_sub_u32 s47, s16, 4
    s_lshl_b32 s47, s47, 11
    s_add_u32 s47, s47, 16384
    s_cmp_lt_u32 s16, 4
    s_cselect_b32 s56, s56, s47
    s_add_u32 s56, s56, 139264
    v_and_b32 v89, 15, v1
    v_lshrrev_b32 v92, 2, v89
    v_and_b32 v93, 3, v1
    v_lshrrev_b32 v94, 4, v1
    v_lshrrev_b32 v95, 3, v1
    v_and_b32 v96, 7, v1
    v_lshlrev_b32 v96, 4, v96
    s_cmp_ge_u32 s16, s46
    s_cbranch_scc1 L_preB_mk
    s_mul_i32 s47, s44, 7
    s_lshl_b32 s45, s45, 2
    s_add_u32 s47, s47, s45
    s_add_u32 s47, s47, s16
    s_cmp_ge_u32 s47, 448
    s_cselect_b32 s48, s38, s36
    s_cselect_b32 s49, s39, s37
    s_cselect_b32 s57, 2097152, 0
    s_cselect_b32 s58, 131072, 0
    s_cselect_b32 s45, 448, 0
    s_add_u32 s57, s57, 8388608
    s_add_u32 s58, s58, 6815744
    s_sub_u32 s47, s47, s45
    s_and_b32 s49, s49, 0xffff
    s_mov_b32 s50, 1835008
    s_mov_b32 s51, 0x00020000
    s_lshr_b32 s45, s47, 4
    s_and_b32 s47, s47, 15
    s_mul_i32 s31, s47, 114688
    s_lshl_b32 s46, s45, 7
    s_add_u32 s31, s31, s46
    s_lshl_b32 s45, s45, 6
    s_add_u32 s45, s45, s47
    s_lshl_b32 s46, s45, 10
    s_add_u32 s57, s57, s46
    s_lshl_b32 s46, s45, 6
    s_add_u32 s58, s58, s46
    s_movk_i32 s46, 3584
    v_mul_lo_u32 v97, v95, s46
    v_add_u32 v97, v97, v96
    s_mov_b32 s52, 28672
    v_lshl_add_u32 v98, v94, 3, v92
    v_lshlrev_b32 v98, 7, v98
    v_lshl_add_u32 v98, v93, 3, v98
    v_add_u32 v98, s56, v98
    s_mov_b32 s59, 0
    s_branch L_predone_mk
L_preB_mk:
    s_mul_i32 s47, s44, 9
    s_sub_u32 s46, s16, s46
    s_add_u32 s47, s47, s46
    s_lshl_b32 s45, s45, 2
    s_add_u32 s47, s47, s45
    v_lshrrev_b32 v101, 1, v94
    v_and_b32 v98, 1, v94
    v_lshlrev_b32 v98, 5, v98
    v_lshl_add_u32 v98, v93, 3, v98
    v_lshl_add_u32 v98, v92, 7, v98
    v_add_u32 v98, s56, v98
    s_cmp_ge_u32 s47, 896
    s_cbranch_scc1 L_prewo_mk
    s_mul_hi_u32 s45, s47, 38347923
    s_mul_i32 s46, s45, 112
    s_sub_u32 s46, s47, s46
    s_mov_b32 s48, s40
    s_and_b32 s49, s41, 0xffff
    s_mov_b32 s50, 1835008
    s_mov_b32 s51, 0x00020000
    s_lshl_b32 s31, s46, 14
    s_lshl_b32 s47, s45, 7
    s_add_u32 s31, s31, s47
    s_mul_i32 s45, s45, 224
    s_add_u32 s45, s45, s46
    s_lshl_b32 s45, s45, 10
    s_add_u32 s57, s45, 12582912
    s_mov_b32 s58, 114688
    v_lshl_add_u32 v98, v101, 10, v98
    s_movk_i32 s53, 512
    s_branch L_preBd_mk
L_prewo_mk:
    s_sub_u32 s47, s47, 896
    s_lshr_b32 s45, s47, 5
    s_and_b32 s46, s47, 31
    s_mov_b32 s48, s32
    s_and_b32 s49, s33, 0xffff
    s_mov_b32 s50, 524288
    s_mov_b32 s51, 0x00020000
    s_lshl_b32 s31, s46, 14
    s_lshl_b32 s47, s45, 7
    s_add_u32 s31, s31, s47
    s_lshl_b32 s45, s45, 6
    s_add_u32 s45, s45, s46
    s_lshl_b32 s45, s45, 10
    s_add_u32 s57, s45, 7340032
    s_mov_b32 s58, 32768
    v_lshl_add_u32 v98, v101, 9, v98
    s_movk_i32 s53, 1024
L_preBd_mk:
    v_lshlrev_b32 v97, 10, v95
    v_add_u32 v97, v97, v96
    s_movk_i32 s52, 8192
    v_add_u32 v99, s53, v98
    s_mov_b32 s59, 1
L_predone_mk:
    s_lshr_b32 s21, s16, 2
    s_mul_i32 s55, s21, 67584
    v_and_b32 v89, 31, v1
    v_lshrrev_b32 v92, 5, v1
    v_lshlrev_b32 v92, 8, v92
    v_lshl_add_u32 v92, v89, 4, v92
    v_mov_b32 v93, 512
    v_cmp_gt_u32 vcc, 16, v89
    s_nop 1
    v_cndmask_b32 v90, v93, v92, vcc
    v_mov_b32 v93, 528
    v_and_b32 v92, 27, v89
    v_cmp_lt_u32 vcc, 16, v92
    s_nop 1
    v_cndmask_b32 v90, v90, v93, vcc
    v_add_u32 v90, 1024, v90
    s_and_b32 s23, s19, 15
    s_mul_i32 s23, s23, 7
    s_add_u32 s23, s23, s16
    s_lshl_b32 s34, s23, 14
    s_add_u32 s35, s34, 10485760
    s_add_u32 s34, s34, 8388608
    s_mul_i32 s28, s18, 224
    s_mul_i32 s29, s16, 14
    s_add_u32 s28, s28, s29
    s_lshl_b32 s28, s28, 10
    s_add_u32 s28, s28, 12582912
    s_add_u32 s29, s28, 114688
    s_cmp_eq_u32 s16, 7
    s_cselect_b32 s34, s28, s34
    s_cselect_b32 s35, s29, s35
    s_lshl_b32 s30, s18, 6
    s_lshl_b32 s21, s16, 2
    s_add_u32 s30, s30, s21
    s_lshl_b32 s30, s30, 10
    s_add_u32 s30, s30, 7340032
    s_waitcnt vmcnt(0) lgkmcnt(0)
    s_barrier
    s_and_b32 s21, s16, 3
    s_lshl_b32 s21, s21, 10
    s_add_u32 s21, s21, 57344
    v_add_u32 v89, s21, v2
    ds_read_b128 v[4:7], v89
    ds_read_b128 v[252:255], v89 offset:4096
    v_mov_b32 v91, 157440
    ds_read_b128 v[56:59], v91
    ds_read_b128 v[60:63], v91 offset:16
    ds_read_b64 v[64:65], v91 offset:32
    v_add_u32 v3, s55, v2
    v_add_u32 v88, s55, v90
    ds_read_b128 v[8:11], v3 offset:0
    ds_read_b128 v[16:19], v88 offset:0
    ds_read_b128 v[20:23], v88 offset:544
    ds_read_b128 v[12:15], v3 offset:2112
    v_mov_b32 v72, 0
    v_mov_b32 v73, 0
    v_mov_b32 v74, 0
    v_mov_b32 v75, 0
    v_mov_b32 v76, 0
    v_mov_b32 v77, 0
    v_mov_b32 v78, 0
    v_mov_b32 v79, 0
    v_mov_b32 v80, 0
    v_mov_b32 v81, 0
    v_mov_b32 v82, 0
    v_mov_b32 v83, 0
    v_mov_b32 v84, 0
    v_mov_b32 v85, 0
    v_mov_b32 v86, 0
    v_mov_b32 v87, 0
    v_mov_b32 v36, 0
    v_mov_b32 v28, 0
    v_mov_b32 v37, 0
    v_mov_b32 v29, 0
    v_mov_b32 v38, 0
    v_mov_b32 v30, 0
    v_mov_b32 v39, 0
    v_mov_b32 v31, 0
    s_waitcnt lgkmcnt(0)
    s_barrier
    v_max3_f32 v56, v56, v57, v58
    v_max3_f32 v60, v60, v61, v62
    v_max3_f32 v56, v56, v59, v60
    v_max_f32 v56, v56, v63
    v_mul_f32 v56, v56, v64
    v_mov_b32 v66, 1153957888
    v_mov_b32 v67, 2071986176
    v_cmp_le_f32 vcc, v56, v66
    v_cmp_le_f32 s[22:23], v65, v67
    s_nop 3
    s_and_b64 vcc, vcc, s[22:23]
    s_cbranch_vccz L_slow_mk
    v_mfma_f32_32x32x16_bf16 v[40:55], v[8:11], v[4:7], 0
    s_nop 15
    v_exp_f32 v40, v40
    v_exp_f32 v41, v41
    v_mfma_f32_32x32x16_bf16 v[72:87], v[28:31], v[36:39], v[72:87]
    ds_read_b128 v[28:31], v88 offset:2656
    v_exp_f32 v42, v42
    v_exp_f32 v43, v43
    v_cvt_pk_bf16_f32 v32, v40, v41
    v_cvt_pk_bf16_f32 v33, v42, v43
    v_exp_f32 v44, v44
    v_exp_f32 v45, v45
    s_waitcnt lgkmcnt(1)
    v_mfma_f32_32x32x16_bf16 v[56:71], v[12:15], v[4:7], 0
    ds_read_b128 v[24:27], v88 offset:2112
    ds_read_b128 v[8:11], v3 offset:4224
    s_add_u32 s63, s63, 16384
    s_mov_b32 m0, s63
    s_nop 0
    buffer_load_dwordx4 v2, s[12:15], s63 offen offset:0 sc1 lds
    buffer_load_dwordx4 v2, s[12:15], s63 offen offset:1024 sc1 lds
    v_exp_f32 v46, v46
    v_exp_f32 v47, v47
    v_cvt_pk_bf16_f32 v34, v44, v45
    v_cvt_pk_bf16_f32 v35, v46, v47
    v_exp_f32 v48, v48
    v_exp_f32 v49, v49
    v_mfma_f32_32x32x16_bf16 v[72:87], v[16:19], v[32:35], v[72:87]
    v_exp_f32 v50, v50
    v_exp_f32 v51, v51
    v_exp_f32 v52, v52
    v_exp_f32 v53, v53
    v_exp_f32 v54, v54
    v_exp_f32 v55, v55
    v_cvt_pk_bf16_f32 v36, v48, v49
    v_cvt_pk_bf16_f32 v37, v50, v51
    v_cvt_pk_bf16_f32 v38, v52, v53
    v_cvt_pk_bf16_f32 v39, v54, v55
    v_exp_f32 v56, v56
    v_exp_f32 v57, v57
    v_mfma_f32_32x32x16_bf16 v[72:87], v[20:23], v[36:39], v[72:87]
    ds_read_b128 v[20:23], v88 offset:4768
    v_exp_f32 v58, v58
    v_exp_f32 v59, v59
    v_cvt_pk_bf16_f32 v32, v56, v57
    v_cvt_pk_bf16_f32 v33, v58, v59
    v_exp_f32 v60, v60
    v_exp_f32 v61, v61
    s_waitcnt lgkmcnt(1)
    v_mfma_f32_32x32x16_bf16 v[40:55], v[8:11], v[4:7], 0
    ds_read_b128 v[16:19], v88 offset:4224
    ds_read_b128 v[12:15], v3 offset:6336
    buffer_load_dwordx4 v2, s[12:15], s63 offen offset:2048 sc1 lds
    buffer_load_dwordx4 v2, s[12:15], s63 offen offset:3072 sc1 lds
    v_exp_f32 v62, v62
    v_exp_f32 v63, v63
    v_cvt_pk_bf16_f32 v34, v60, v61
    v_cvt_pk_bf16_f32 v35, v62, v63
    v_exp_f32 v64, v64
    v_exp_f32 v65, v65
    v_mfma_f32_32x32x16_bf16 v[72:87], v[24:27], v[32:35], v[72:87]
    v_exp_f32 v66, v66
    v_exp_f32 v67, v67
    v_exp_f32 v68, v68
    v_exp_f32 v69, v69
    v_exp_f32 v70, v70
    v_exp_f32 v71, v71
    v_cvt_pk_bf16_f32 v36, v64, v65
    v_cvt_pk_bf16_f32 v37, v66, v67
    v_cvt_pk_bf16_f32 v38, v68, v69
    v_cvt_pk_bf16_f32 v39, v70, v71
    v_exp_f32 v40, v40
    v_exp_f32 v41, v41
    v_mfma_f32_32x32x16_bf16 v[72:87], v[28:31], v[36:39], v[72:87]
    ds_read_b128 v[28:31], v88 offset:6880
    v_exp_f32 v42, v42
    v_exp_f32 v43, v43
    v_cvt_pk_bf16_f32 v32, v40, v41
    v_cvt_pk_bf16_f32 v33, v42, v43
    v_exp_f32 v44, v44
    v_exp_f32 v45, v45
    s_waitcnt lgkmcnt(1)
    v_mfma_f32_32x32x16_bf16 v[56:71], v[12:15], v[4:7], 0
    ds_read_b128 v[24:27], v88 offset:6336
    ds_read_b128 v[8:11], v3 offset:8448
    s_add_u32 s63, s63, 16384
    s_mov_b32 m0, s63
    s_nop 0
    buffer_load_dwordx4 v2, s[12:15], s63 offen offset:0 sc1 lds
    buffer_load_dwordx4 v2, s[12:15], s63 offen offset:1024 sc1 lds
    v_exp_f32 v46, v46
    v_exp_f32 v47, v47
    v_cvt_pk_bf16_f32 v34, v44, v45
    v_cvt_pk_bf16_f32 v35, v46, v47
    v_exp_f32 v48, v48
    v_exp_f32 v49, v49
    v_mfma_f32_32x32x16_bf16 v[72:87], v[16:19], v[32:35], v[72:87]
    v_exp_f32 v50, v50
    v_exp_f32 v51, v51
    v_exp_f32 v52, v52
    v_exp_f32 v53, v53
    v_exp_f32 v54, v54
    v_exp_f32 v55, v55
    v_cvt_pk_bf16_f32 v36, v48, v49
    v_cvt_pk_bf16_f32 v37, v50, v51
    v_cvt_pk_bf16_f32 v38, v52, v53
    v_cvt_pk_bf16_f32 v39, v54, v55
    v_exp_f32 v56, v56
    v_exp_f32 v57, v57
    v_mfma_f32_32x32x16_bf16 v[72:87], v[20:23], v[36:39], v[72:87]
    ds_read_b128 v[20:23], v88 offset:8992
    v_exp_f32 v58, v58
    v_exp_f32 v59, v59
    v_cvt_pk_bf16_f32 v32, v56, v57
    v_cvt_pk_bf16_f32 v33, v58, v59
    v_exp_f32 v60, v60
    v_exp_f32 v61, v61
    s_waitcnt lgkmcnt(1)
    v_mfma_f32_32x32x16_bf16 v[40:55], v[8:11], v[4:7], 0
    ds_read_b128 v[16:19], v88 offset:8448
    ds_read_b128 v[12:15], v3 offset:10560
    buffer_load_dwordx4 v2, s[12:15], s63 offen offset:2048 sc1 lds
    buffer_load_dwordx4 v2, s[12:15], s63 offen offset:3072 sc1 lds
    v_exp_f32 v62, v62
    v_exp_f32 v63, v63
    v_cvt_pk_bf16_f32 v34, v60, v61
    v_cvt_pk_bf16_f32 v35, v62, v63
    v_exp_f32 v64, v64
    v_exp_f32 v65, v65
    v_mfma_f32_32x32x16_bf16 v[72:87], v[24:27], v[32:35], v[72:87]
    v_exp_f32 v66, v66
    v_exp_f32 v67, v67
    v_exp_f32 v68, v68
    v_exp_f32 v69, v69
    v_exp_f32 v70, v70
    v_exp_f32 v71, v71
    v_cvt_pk_bf16_f32 v36, v64, v65
    v_cvt_pk_bf16_f32 v37, v66, v67
    v_cvt_pk_bf16_f32 v38, v68, v69
    v_cvt_pk_bf16_f32 v39, v70, v71
    v_exp_f32 v40, v40
    v_exp_f32 v41, v41
    v_mfma_f32_32x32x16_bf16 v[72:87], v[28:31], v[36:39], v[72:87]
    ds_read_b128 v[28:31], v88 offset:11104
    v_exp_f32 v42, v42
    v_exp_f32 v43, v43
    v_cvt_pk_bf16_f32 v32, v40, v41
    v_cvt_pk_bf16_f32 v33, v42, v43
    v_exp_f32 v44, v44
    v_exp_f32 v45, v45
    s_waitcnt lgkmcnt(1)
    v_mfma_f32_32x32x16_bf16 v[56:71], v[12:15], v[4:7], 0
    ds_read_b128 v[24:27], v88 offset:10560
    ds_read_b128 v[8:11], v3 offset:12672
    s_add_u32 s63, s63, 16384
    s_mov_b32 m0, s63
    s_nop 0
    buffer_load_dwordx4 v2, s[12:15], s63 offen offset:0 sc1 lds
    buffer_load_dwordx4 v2, s[12:15], s63 offen offset:1024 sc1 lds
    v_exp_f32 v46, v46
    v_exp_f32 v47, v47
    v_cvt_pk_bf16_f32 v34, v44, v45
    v_cvt_pk_bf16_f32 v35, v46, v47
    v_exp_f32 v48, v48
    v_exp_f32 v49, v49
    v_mfma_f32_32x32x16_bf16 v[72:87], v[16:19], v[32:35], v[72:87]
    v_exp_f32 v50, v50
    v_exp_f32 v51, v51
    v_exp_f32 v52, v52
    v_exp_f32 v53, v53
    v_exp_f32 v54, v54
    v_exp_f32 v55, v55
    v_cvt_pk_bf16_f32 v36, v48, v49
    v_cvt_pk_bf16_f32 v37, v50, v51
    v_cvt_pk_bf16_f32 v38, v52, v53
    v_cvt_pk_bf16_f32 v39, v54, v55
    s_waitcnt vmcnt(6)
    s_barrier
    v_exp_f32 v56, v56
    v_exp_f32 v57, v57
    v_mfma_f32_32x32x16_bf16 v[72:87], v[20:23], v[36:39], v[72:87]
    ds_read_b128 v[20:23], v88 offset:13216
    v_exp_f32 v58, v58
    v_exp_f32 v59, v59
    v_cvt_pk_bf16_f32 v32, v56, v57
    v_cvt_pk_bf16_f32 v33, v58, v59
    v_exp_f32 v60, v60
    v_exp_f32 v61, v61
    s_waitcnt lgkmcnt(1)
    v_mfma_f32_32x32x16_bf16 v[40:55], v[8:11], v[4:7], 0
    ds_read_b128 v[16:19], v88 offset:12672
    ds_read_b128 v[12:15], v3 offset:14784
    buffer_load_dwordx4 v2, s[12:15], s63 offen offset:2048 sc1 lds
    buffer_load_dwordx4 v2, s[12:15], s63 offen offset:3072 sc1 lds
    v_exp_f32 v62, v62
    v_exp_f32 v63, v63
    v_cvt_pk_bf16_f32 v34, v60, v61
    v_cvt_pk_bf16_f32 v35, v62, v63
    v_exp_f32 v64, v64
    v_exp_f32 v65, v65
    v_mfma_f32_32x32x16_bf16 v[72:87], v[24:27], v[32:35], v[72:87]
    v_exp_f32 v66, v66
    v_exp_f32 v67, v67
    v_exp_f32 v68, v68
    v_exp_f32 v69, v69
    v_exp_f32 v70, v70
    v_exp_f32 v71, v71
    v_cvt_pk_bf16_f32 v36, v64, v65
    v_cvt_pk_bf16_f32 v37, v66, v67
    v_cvt_pk_bf16_f32 v38, v68, v69
    v_cvt_pk_bf16_f32 v39, v70, v71
    v_exp_f32 v40, v40
    v_exp_f32 v41, v41
    v_mfma_f32_32x32x16_bf16 v[72:87], v[28:31], v[36:39], v[72:87]
    ds_read_b128 v[28:31], v88 offset:15328
    v_exp_f32 v42, v42
    v_exp_f32 v43, v43
    v_cvt_pk_bf16_f32 v32, v40, v41
    v_cvt_pk_bf16_f32 v33, v42, v43
    v_exp_f32 v44, v44
    v_exp_f32 v45, v45
    s_waitcnt lgkmcnt(1)
    v_mfma_f32_32x32x16_bf16 v[56:71], v[12:15], v[4:7], 0
    ds_read_b128 v[24:27], v88 offset:14784
    ds_read_b128 v[8:11], v3 offset:16896
    s_and_b32 s63, s16, 3
    s_lshl_b32 s63, s63, 10
    s_add_u32 s63, s63, 131072
    s_mov_b32 m0, s63
    s_nop 0
    buffer_load_dwordx4 v2, s[12:15], s63 offen sc1 lds
    v_exp_f32 v46, v46
    v_exp_f32 v47, v47
    v_cvt_pk_bf16_f32 v34, v44, v45
    v_cvt_pk_bf16_f32 v35, v46, v47
    v_exp_f32 v48, v48
    v_exp_f32 v49, v49
    v_mfma_f32_32x32x16_bf16 v[72:87], v[16:19], v[32:35], v[72:87]
    v_exp_f32 v50, v50
    v_exp_f32 v51, v51
    v_exp_f32 v52, v52
    v_exp_f32 v53, v53
    v_exp_f32 v54, v54
    v_exp_f32 v55, v55
    v_cvt_pk_bf16_f32 v36, v48, v49
    v_cvt_pk_bf16_f32 v37, v50, v51
    v_cvt_pk_bf16_f32 v38, v52, v53
    v_cvt_pk_bf16_f32 v39, v54, v55
    v_exp_f32 v56, v56
    v_exp_f32 v57, v57
    v_mfma_f32_32x32x16_bf16 v[72:87], v[20:23], v[36:39], v[72:87]
    ds_read_b128 v[20:23], v88 offset:17440
    v_exp_f32 v58, v58
    v_exp_f32 v59, v59
    v_cvt_pk_bf16_f32 v32, v56, v57
    v_cvt_pk_bf16_f32 v33, v58, v59
    v_exp_f32 v60, v60
    v_exp_f32 v61, v61
    s_waitcnt lgkmcnt(1)
    v_mfma_f32_32x32x16_bf16 v[40:55], v[8:11], v[4:7], 0
    ds_read_b128 v[16:19], v88 offset:16896
    ds_read_b128 v[12:15], v3 offset:19008
    v_exp_f32 v62, v62
    v_exp_f32 v63, v63
    v_cvt_pk_bf16_f32 v34, v60, v61
    v_cvt_pk_bf16_f32 v35, v62, v63
    v_exp_f32 v64, v64
    v_exp_f32 v65, v65
    v_mfma_f32_32x32x16_bf16 v[72:87], v[24:27], v[32:35], v[72:87]
    v_exp_f32 v66, v66
    v_exp_f32 v67, v67
    v_exp_f32 v68, v68
    v_exp_f32 v69, v69
    v_exp_f32 v70, v70
    v_exp_f32 v71, v71
    v_cvt_pk_bf16_f32 v36, v64, v65
    v_cvt_pk_bf16_f32 v37, v66, v67
    v_cvt_pk_bf16_f32 v38, v68, v69
    v_cvt_pk_bf16_f32 v39, v70, v71
    v_exp_f32 v40, v40
    v_exp_f32 v41, v41
    v_mfma_f32_32x32x16_bf16 v[72:87], v[28:31], v[36:39], v[72:87]
    ds_read_b128 v[28:31], v88 offset:19552
    v_exp_f32 v42, v42
    v_exp_f32 v43, v43
    v_cvt_pk_bf16_f32 v32, v40, v41
    v_cvt_pk_bf16_f32 v33, v42, v43
    v_exp_f32 v44, v44
    v_exp_f32 v45, v45
    s_waitcnt lgkmcnt(1)
    v_mfma_f32_32x32x16_bf16 v[56:71], v[12:15], v[4:7], 0
    ds_read_b128 v[24:27], v88 offset:19008
    ds_read_b128 v[8:11], v3 offset:21120
    v_exp_f32 v46, v46
    v_exp_f32 v47, v47
    v_cvt_pk_bf16_f32 v34, v44, v45
    v_cvt_pk_bf16_f32 v35, v46, v47
    v_exp_f32 v48, v48
    v_exp_f32 v49, v49
    v_mfma_f32_32x32x16_bf16 v[72:87], v[16:19], v[32:35], v[72:87]
    v_exp_f32 v50, v50
    v_exp_f32 v51, v51
    v_exp_f32 v52, v52
    v_exp_f32 v53, v53
    v_exp_f32 v54, v54
    v_exp_f32 v55, v55
    v_cvt_pk_bf16_f32 v36, v48, v49
    v_cvt_pk_bf16_f32 v37, v50, v51
    v_cvt_pk_bf16_f32 v38, v52, v53
    v_cvt_pk_bf16_f32 v39, v54, v55
    v_exp_f32 v56, v56
    v_exp_f32 v57, v57
    v_mfma_f32_32x32x16_bf16 v[72:87], v[20:23], v[36:39], v[72:87]
    ds_read_b128 v[20:23], v88 offset:21664
    v_exp_f32 v58, v58
    v_exp_f32 v59, v59
    v_cvt_pk_bf16_f32 v32, v56, v57
    v_cvt_pk_bf16_f32 v33, v58, v59
    v_exp_f32 v60, v60
    v_exp_f32 v61, v61
    s_waitcnt lgkmcnt(1)
    v_mfma_f32_32x32x16_bf16 v[40:55], v[8:11], v[4:7], 0
    ds_read_b128 v[16:19], v88 offset:21120
    ds_read_b128 v[12:15], v3 offset:23232
    s_add_u32 m0, s56, 0
    s_nop 0
    buffer_load_dwordx4 v97, s[48:51], s31 offen lds
    s_add_u32 s31, s31, s52
    v_exp_f32 v62, v62
    v_exp_f32 v63, v63
    v_cvt_pk_bf16_f32 v34, v60, v61
    v_cvt_pk_bf16_f32 v35, v62, v63
    v_exp_f32 v64, v64
    v_exp_f32 v65, v65
    v_mfma_f32_32x32x16_bf16 v[72:87], v[24:27], v[32:35], v[72:87]
    v_exp_f32 v66, v66
    v_exp_f32 v67, v67
    v_exp_f32 v68, v68
    v_exp_f32 v69, v69
    v_exp_f32 v70, v70
    v_exp_f32 v71, v71
    v_cvt_pk_bf16_f32 v36, v64, v65
    v_cvt_pk_bf16_f32 v37, v66, v67
    v_cvt_pk_bf16_f32 v38, v68, v69
    v_cvt_pk_bf16_f32 v39, v70, v71
    v_exp_f32 v40, v40
    v_exp_f32 v41, v41
    v_mfma_f32_32x32x16_bf16 v[72:87], v[28:31], v[36:39], v[72:87]
    ds_read_b128 v[28:31], v88 offset:23776
    v_exp_f32 v42, v42
    v_exp_f32 v43, v43
    v_cvt_pk_bf16_f32 v32, v40, v41
    v_cvt_pk_bf16_f32 v33, v42, v43
    v_exp_f32 v44, v44
    v_exp_f32 v45, v45
    s_waitcnt lgkmcnt(1)
    v_mfma_f32_32x32x16_bf16 v[56:71], v[12:15], v[4:7], 0
    ds_read_b128 v[24:27], v88 offset:23232
    ds_read_b128 v[8:11], v3 offset:25344
    s_add_u32 m0, s56, 1024
    s_nop 0
    buffer_load_dwordx4 v97, s[48:51], s31 offen lds
    s_add_u32 s31, s31, s52
    v_exp_f32 v46, v46
    v_exp_f32 v47, v47
    v_cvt_pk_bf16_f32 v34, v44, v45
    v_cvt_pk_bf16_f32 v35, v46, v47
    v_exp_f32 v48, v48
    v_exp_f32 v49, v49
    v_mfma_f32_32x32x16_bf16 v[72:87], v[16:19], v[32:35], v[72:87]
    v_exp_f32 v50, v50
    v_exp_f32 v51, v51
    v_exp_f32 v52, v52
    v_exp_f32 v53, v53
    v_exp_f32 v54, v54
    v_exp_f32 v55, v55
    v_cvt_pk_bf16_f32 v36, v48, v49
    v_cvt_pk_bf16_f32 v37, v50, v51
    v_cvt_pk_bf16_f32 v38, v52, v53
    v_cvt_pk_bf16_f32 v39, v54, v55
    v_exp_f32 v56, v56
    v_exp_f32 v57, v57
    v_mfma_f32_32x32x16_bf16 v[72:87], v[20:23], v[36:39], v[72:87]
    ds_read_b128 v[20:23], v88 offset:25888
    v_exp_f32 v58, v58
    v_exp_f32 v59, v59
    v_cvt_pk_bf16_f32 v32, v56, v57
    v_cvt_pk_bf16_f32 v33, v58, v59
    v_exp_f32 v60, v60
    v_exp_f32 v61, v61
    s_waitcnt lgkmcnt(1)
    v_mfma_f32_32x32x16_bf16 v[40:55], v[8:11], v[4:7], 0
    ds_read_b128 v[16:19], v88 offset:25344
    ds_read_b128 v[12:15], v3 offset:27456
    s_lshl_b32 s21, s52, 1
    s_cmp_eq_u32 s59, 1
    s_cselect_b32 s21, s21, 0
    s_sub_u32 s31, s31, s21
    s_add_u32 s21, s56, 2048
    s_add_u32 s22, s56, 0
    s_cmp_eq_u32 s59, 1
    s_cselect_b32 m0, s22, s21
    s_nop 0
    buffer_load_dwordx4 v97, s[48:51], s31 offen lds
    s_add_u32 s31, s31, s52
    s_add_u32 s21, s56, 3072
    s_add_u32 s22, s56, 1024
    s_cmp_eq_u32 s59, 1
    s_cselect_b32 m0, s22, s21
    s_nop 0
    buffer_load_dwordx4 v97, s[48:51], s31 offen lds
    s_add_u32 s31, s31, s52
    v_exp_f32 v62, v62
    v_exp_f32 v63, v63
    v_cvt_pk_bf16_f32 v34, v60, v61
    v_cvt_pk_bf16_f32 v35, v62, v63
    v_exp_f32 v64, v64
    v_exp_f32 v65, v65
    v_mfma_f32_32x32x16_bf16 v[72:87], v[24:27], v[32:35], v[72:87]
    v_exp_f32 v66, v66
    v_exp_f32 v67, v67
    v_exp_f32 v68, v68
    v_exp_f32 v69, v69
    v_exp_f32 v70, v70
    v_exp_f32 v71, v71
    v_cvt_pk_bf16_f32 v36, v64, v65
    v_cvt_pk_bf16_f32 v37, v66, v67
    v_cvt_pk_bf16_f32 v38, v68, v69
    v_cvt_pk_bf16_f32 v39, v70, v71
    s_waitcnt vmcnt(4)
    s_barrier
    v_exp_f32 v40, v40
    v_exp_f32 v41, v41
    v_mfma_f32_32x32x16_bf16 v[72:87], v[28:31], v[36:39], v[72:87]
    ds_read_b128 v[28:31], v88 offset:28000
    v_exp_f32 v42, v42
    v_exp_f32 v43, v43
    v_cvt_pk_bf16_f32 v32, v40, v41
    v_cvt_pk_bf16_f32 v33, v42, v43
    v_exp_f32 v44, v44
    v_exp_f32 v45, v45
    s_waitcnt lgkmcnt(1)
    v_mfma_f32_32x32x16_bf16 v[56:71], v[12:15], v[4:7], 0
    ds_read_b128 v[24:27], v88 offset:27456
    ds_read_b128 v[8:11], v3 offset:29568
    v_exp_f32 v46, v46
    v_exp_f32 v47, v47
    v_cvt_pk_bf16_f32 v34, v44, v45
    v_cvt_pk_bf16_f32 v35, v46, v47
    v_exp_f32 v48, v48
    v_exp_f32 v49, v49
    v_mfma_f32_32x32x16_bf16 v[72:87], v[16:19], v[32:35], v[72:87]
    v_exp_f32 v50, v50
    v_exp_f32 v51, v51
    v_exp_f32 v52, v52
    v_exp_f32 v53, v53
    v_exp_f32 v54, v54
    v_exp_f32 v55, v55
    v_cvt_pk_bf16_f32 v36, v48, v49
    v_cvt_pk_bf16_f32 v37, v50, v51
    v_cvt_pk_bf16_f32 v38, v52, v53
    v_cvt_pk_bf16_f32 v39, v54, v55
    v_exp_f32 v56, v56
    v_exp_f32 v57, v57
    v_mfma_f32_32x32x16_bf16 v[72:87], v[20:23], v[36:39], v[72:87]
    ds_read_b128 v[20:23], v88 offset:30112
    v_exp_f32 v58, v58
    v_exp_f32 v59, v59
    v_cvt_pk_bf16_f32 v32, v56, v57
    v_cvt_pk_bf16_f32 v33, v58, v59
    v_exp_f32 v60, v60
    v_exp_f32 v61, v61
    s_waitcnt lgkmcnt(1)
    v_mfma_f32_32x32x16_bf16 v[40:55], v[8:11], v[4:7], 0
    ds_read_b128 v[16:19], v88 offset:29568
    ds_read_b128 v[12:15], v3 offset:31680
    v_exp_f32 v62, v62
    v_exp_f32 v63, v63
    v_cvt_pk_bf16_f32 v34, v60, v61
    v_cvt_pk_bf16_f32 v35, v62, v63
    v_exp_f32 v64, v64
    v_exp_f32 v65, v65
    v_mfma_f32_32x32x16_bf16 v[72:87], v[24:27], v[32:35], v[72:87]
    v_exp_f32 v66, v66
    v_exp_f32 v67, v67
    v_exp_f32 v68, v68
    v_exp_f32 v69, v69
    v_exp_f32 v70, v70
    v_exp_f32 v71, v71
    v_cvt_pk_bf16_f32 v36, v64, v65
    v_cvt_pk_bf16_f32 v37, v66, v67
    v_cvt_pk_bf16_f32 v38, v68, v69
    v_cvt_pk_bf16_f32 v39, v70, v71
    v_exp_f32 v40, v40
    v_exp_f32 v41, v41
    v_mfma_f32_32x32x16_bf16 v[72:87], v[28:31], v[36:39], v[72:87]
    ds_read_b128 v[28:31], v88 offset:32224
    v_exp_f32 v42, v42
    v_exp_f32 v43, v43
    v_cvt_pk_bf16_f32 v32, v40, v41
    v_cvt_pk_bf16_f32 v33, v42, v43
    v_exp_f32 v44, v44
    v_exp_f32 v45, v45
    s_waitcnt lgkmcnt(1)
    v_mfma_f32_32x32x16_bf16 v[56:71], v[12:15], v[4:7], 0
    ds_read_b128 v[24:27], v88 offset:31680
    ds_read_b128 v[8:11], v3 offset:33792
    v_exp_f32 v46, v46
    v_exp_f32 v47, v47
    v_cvt_pk_bf16_f32 v34, v44, v45
    v_cvt_pk_bf16_f32 v35, v46, v47
    v_exp_f32 v48, v48
    v_exp_f32 v49, v49
    v_mfma_f32_32x32x16_bf16 v[72:87], v[16:19], v[32:35], v[72:87]
    v_exp_f32 v50, v50
    v_exp_f32 v51, v51
    v_exp_f32 v52, v52
    v_exp_f32 v53, v53
    v_exp_f32 v54, v54
    v_exp_f32 v55, v55
    v_cvt_pk_bf16_f32 v36, v48, v49
    v_cvt_pk_bf16_f32 v37, v50, v51
    v_cvt_pk_bf16_f32 v38, v52, v53
    v_cvt_pk_bf16_f32 v39, v54, v55
    v_exp_f32 v56, v56
    v_exp_f32 v57, v57
    v_mfma_f32_32x32x16_bf16 v[72:87], v[20:23], v[36:39], v[72:87]
    ds_read_b128 v[20:23], v88 offset:34336
    v_exp_f32 v58, v58
    v_exp_f32 v59, v59
    v_cvt_pk_bf16_f32 v32, v56, v57
    v_cvt_pk_bf16_f32 v33, v58, v59
    v_exp_f32 v60, v60
    v_exp_f32 v61, v61
    s_waitcnt lgkmcnt(1)
    v_mfma_f32_32x32x16_bf16 v[40:55], v[8:11], v[4:7], 0
    ds_read_b128 v[16:19], v88 offset:33792
    ds_read_b128 v[12:15], v3 offset:35904
    v_exp_f32 v62, v62
    v_exp_f32 v63, v63
    v_cvt_pk_bf16_f32 v34, v60, v61
    v_cvt_pk_bf16_f32 v35, v62, v63
    v_exp_f32 v64, v64
    v_exp_f32 v65, v65
    v_mfma_f32_32x32x16_bf16 v[72:87], v[24:27], v[32:35], v[72:87]
    v_exp_f32 v66, v66
    v_exp_f32 v67, v67
    v_exp_f32 v68, v68
    v_exp_f32 v69, v69
    v_exp_f32 v70, v70
    v_exp_f32 v71, v71
    v_cvt_pk_bf16_f32 v36, v64, v65
    v_cvt_pk_bf16_f32 v37, v66, v67
    v_cvt_pk_bf16_f32 v38, v68, v69
    v_cvt_pk_bf16_f32 v39, v70, v71
    v_add_u32 v3, 33792, v3
    v_add_u32 v88, 33792, v88
    v_exp_f32 v40, v40
    v_exp_f32 v41, v41
    v_mfma_f32_32x32x16_bf16 v[72:87], v[28:31], v[36:39], v[72:87]
    ds_read_b128 v[28:31], v88 offset:2656
    v_exp_f32 v42, v42
    v_exp_f32 v43, v43
    v_cvt_pk_bf16_f32 v32, v40, v41
    v_cvt_pk_bf16_f32 v33, v42, v43
    v_exp_f32 v44, v44
    v_exp_f32 v45, v45
    s_waitcnt lgkmcnt(1)
    v_mfma_f32_32x32x16_bf16 v[56:71], v[12:15], v[4:7], 0
    ds_read_b128 v[24:27], v88 offset:2112
    ds_read_b128 v[8:11], v3 offset:4224
    v_exp_f32 v46, v46
    v_exp_f32 v47, v47
    v_cvt_pk_bf16_f32 v34, v44, v45
    v_cvt_pk_bf16_f32 v35, v46, v47
    v_exp_f32 v48, v48
    v_exp_f32 v49, v49
    v_mfma_f32_32x32x16_bf16 v[72:87], v[16:19], v[32:35], v[72:87]
    v_exp_f32 v50, v50
    v_exp_f32 v51, v51
    v_exp_f32 v52, v52
    v_exp_f32 v53, v53
    v_exp_f32 v54, v54
    v_exp_f32 v55, v55
    v_cvt_pk_bf16_f32 v36, v48, v49
    v_cvt_pk_bf16_f32 v37, v50, v51
    v_cvt_pk_bf16_f32 v38, v52, v53
    v_cvt_pk_bf16_f32 v39, v54, v55
    v_exp_f32 v56, v56
    v_exp_f32 v57, v57
    v_mfma_f32_32x32x16_bf16 v[72:87], v[20:23], v[36:39], v[72:87]
    ds_read_b128 v[20:23], v88 offset:4768
    v_exp_f32 v58, v58
    v_exp_f32 v59, v59
    v_cvt_pk_bf16_f32 v32, v56, v57
    v_cvt_pk_bf16_f32 v33, v58, v59
    v_exp_f32 v60, v60
    v_exp_f32 v61, v61
    s_waitcnt lgkmcnt(1)
    v_mfma_f32_32x32x16_bf16 v[40:55], v[8:11], v[4:7], 0
    ds_read_b128 v[16:19], v88 offset:4224
    ds_read_b128 v[12:15], v3 offset:6336
    v_exp_f32 v62, v62
    v_exp_f32 v63, v63
    v_cvt_pk_bf16_f32 v34, v60, v61
    v_cvt_pk_bf16_f32 v35, v62, v63
    v_exp_f32 v64, v64
    v_exp_f32 v65, v65
    v_mfma_f32_32x32x16_bf16 v[72:87], v[24:27], v[32:35], v[72:87]
    v_exp_f32 v66, v66
    v_exp_f32 v67, v67
    v_exp_f32 v68, v68
    v_exp_f32 v69, v69
    v_exp_f32 v70, v70
    v_exp_f32 v71, v71
    v_cvt_pk_bf16_f32 v36, v64, v65
    v_cvt_pk_bf16_f32 v37, v66, v67
    v_cvt_pk_bf16_f32 v38, v68, v69
    v_cvt_pk_bf16_f32 v39, v70, v71
    s_waitcnt vmcnt(0)
    s_cmp_eq_u32 s59, 1
    s_cbranch_scc1 L_pb_19
    ds_read_b64_tr_b16 v[104:105], v98 offset:0
    ds_read_b64_tr_b16 v[106:107], v98 offset:512
    ds_read_b64_tr_b16 v[108:109], v98 offset:32
    ds_read_b64_tr_b16 v[110:111], v98 offset:544
    ds_read_b64_tr_b16 v[112:113], v98 offset:64
    ds_read_b64_tr_b16 v[114:115], v98 offset:576
    ds_read_b64_tr_b16 v[116:117], v98 offset:96
    ds_read_b64_tr_b16 v[118:119], v98 offset:608
    v_mov_b32 v100, 0x3f803f80
    v_mov_b32 v101, 0x3f803f80
    v_mov_b32 v102, 0x3f803f80
    v_mov_b32 v103, 0x3f803f80
    s_waitcnt lgkmcnt(0)
    buffer_store_dwordx4 v[104:107], v2, s[8:11], s57 offen sc1
    v_mfma_f32_16x16x32_bf16 v[120:123], v[104:107], v[100:103], 0
    s_add_u32 s57, s57, 16384
    buffer_store_dwordx4 v[108:111], v2, s[8:11], s57 offen sc1
    v_mfma_f32_16x16x32_bf16 v[124:127], v[108:111], v[100:103], 0
    s_add_u32 s57, s57, 16384
    buffer_store_dwordx4 v[112:115], v2, s[8:11], s57 offen sc1
    v_mfma_f32_16x16x32_bf16 v[128:131], v[112:115], v[100:103], 0
    s_add_u32 s57, s57, 16384
    buffer_store_dwordx4 v[116:119], v2, s[8:11], s57 offen sc1
    v_mfma_f32_16x16x32_bf16 v[132:135], v[116:119], v[100:103], 0
    s_add_u32 s57, s57, 16384
    v_lshrrev_b32 v96, 4, v1
    v_lshlrev_b32 v96, 4, v96
    s_mov_b32 exec_lo, 0x00010001
    s_mov_b32 exec_hi, 0x00010001
    s_nop 4
    buffer_store_dwordx4 v[120:123], v96, s[8:11], s58 offen offset:0 sc1
    buffer_store_dwordx4 v[124:127], v96, s[8:11], s58 offen offset:1024 sc1
    buffer_store_dwordx4 v[128:131], v96, s[8:11], s58 offen offset:2048 sc1
    buffer_store_dwordx4 v[132:135], v96, s[8:11], s58 offen offset:3072 sc1
    s_mov_b64 exec, -1
    s_branch L_pe_20
L_pb_19:
    ds_read_b64_tr_b16 v[104:105], v98 offset:0
    ds_read_b64_tr_b16 v[106:107], v99 offset:0
    ds_read_b64_tr_b16 v[108:109], v98 offset:64
    ds_read_b64_tr_b16 v[110:111], v99 offset:64
    s_waitcnt lgkmcnt(0)
    buffer_store_dwordx4 v[104:107], v2, s[8:11], s57 offen sc1
    s_add_u32 s57, s57, s58
    buffer_store_dwordx4 v[108:111], v2, s[8:11], s57 offen sc1
    s_add_u32 s57, s57, s58
L_pe_20:
    v_exp_f32 v40, v40
    v_exp_f32 v41, v41
    v_mfma_f32_32x32x16_bf16 v[72:87], v[28:31], v[36:39], v[72:87]
    ds_read_b128 v[28:31], v88 offset:6880
    v_exp_f32 v42, v42
    v_exp_f32 v43, v43
    v_cvt_pk_bf16_f32 v32, v40, v41
    v_cvt_pk_bf16_f32 v33, v42, v43
    v_exp_f32 v44, v44
    v_exp_f32 v45, v45
    s_waitcnt lgkmcnt(1)
    v_mfma_f32_32x32x16_bf16 v[56:71], v[12:15], v[4:7], 0
    ds_read_b128 v[24:27], v88 offset:6336
    ds_read_b128 v[8:11], v3 offset:8448
    v_exp_f32 v46, v46
    v_exp_f32 v47, v47
    v_cvt_pk_bf16_f32 v34, v44, v45
    v_cvt_pk_bf16_f32 v35, v46, v47
    v_exp_f32 v48, v48
    v_exp_f32 v49, v49
    v_mfma_f32_32x32x16_bf16 v[72:87], v[16:19], v[32:35], v[72:87]
    v_exp_f32 v50, v50
    v_exp_f32 v51, v51
    v_exp_f32 v52, v52
    v_exp_f32 v53, v53
    v_exp_f32 v54, v54
    v_exp_f32 v55, v55
    v_cvt_pk_bf16_f32 v36, v48, v49
    v_cvt_pk_bf16_f32 v37, v50, v51
    v_cvt_pk_bf16_f32 v38, v52, v53
    v_cvt_pk_bf16_f32 v39, v54, v55
    v_exp_f32 v56, v56
    v_exp_f32 v57, v57
    v_mfma_f32_32x32x16_bf16 v[72:87], v[20:23], v[36:39], v[72:87]
    ds_read_b128 v[20:23], v88 offset:8992
    v_exp_f32 v58, v58
    v_exp_f32 v59, v59
    v_cvt_pk_bf16_f32 v32, v56, v57
    v_cvt_pk_bf16_f32 v33, v58, v59
    v_exp_f32 v60, v60
    v_exp_f32 v61, v61
    s_waitcnt lgkmcnt(1)
    v_mfma_f32_32x32x16_bf16 v[40:55], v[8:11], v[4:7], 0
    ds_read_b128 v[16:19], v88 offset:8448
    ds_read_b128 v[12:15], v3 offset:10560
    v_exp_f32 v62, v62
    v_exp_f32 v63, v63
    v_cvt_pk_bf16_f32 v34, v60, v61
    v_cvt_pk_bf16_f32 v35, v62, v63
    v_exp_f32 v64, v64
    v_exp_f32 v65, v65
    v_mfma_f32_32x32x16_bf16 v[72:87], v[24:27], v[32:35], v[72:87]
    v_exp_f32 v66, v66
    v_exp_f32 v67, v67
    v_exp_f32 v68, v68
    v_exp_f32 v69, v69
    v_exp_f32 v70, v70
    v_exp_f32 v71, v71
    v_cvt_pk_bf16_f32 v36, v64, v65
    v_cvt_pk_bf16_f32 v37, v66, v67
    v_cvt_pk_bf16_f32 v38, v68, v69
    v_cvt_pk_bf16_f32 v39, v70, v71
    v_exp_f32 v40, v40
    v_exp_f32 v41, v41
    v_mfma_f32_32x32x16_bf16 v[72:87], v[28:31], v[36:39], v[72:87]
    ds_read_b128 v[28:31], v88 offset:11104
    v_exp_f32 v42, v42
    v_exp_f32 v43, v43
    v_cvt_pk_bf16_f32 v32, v40, v41
    v_cvt_pk_bf16_f32 v33, v42, v43
    v_exp_f32 v44, v44
    v_exp_f32 v45, v45
    s_waitcnt lgkmcnt(1)
    v_mfma_f32_32x32x16_bf16 v[56:71], v[12:15], v[4:7], 0
    ds_read_b128 v[24:27], v88 offset:10560
    ds_read_b128 v[8:11], v3 offset:12672
    v_exp_f32 v46, v46
    v_exp_f32 v47, v47
    v_cvt_pk_bf16_f32 v34, v44, v45
    v_cvt_pk_bf16_f32 v35, v46, v47
    v_exp_f32 v48, v48
    v_exp_f32 v49, v49
    v_mfma_f32_32x32x16_bf16 v[72:87], v[16:19], v[32:35], v[72:87]
    v_exp_f32 v50, v50
    v_exp_f32 v51, v51
    v_exp_f32 v52, v52
    v_exp_f32 v53, v53
    v_exp_f32 v54, v54
    v_exp_f32 v55, v55
    v_cvt_pk_bf16_f32 v36, v48, v49
    v_cvt_pk_bf16_f32 v37, v50, v51
    v_cvt_pk_bf16_f32 v38, v52, v53
    v_cvt_pk_bf16_f32 v39, v54, v55
    v_exp_f32 v56, v56
    v_exp_f32 v57, v57
    v_mfma_f32_32x32x16_bf16 v[72:87], v[20:23], v[36:39], v[72:87]
    ds_read_b128 v[20:23], v88 offset:13216
    v_exp_f32 v58, v58
    v_exp_f32 v59, v59
    v_cvt_pk_bf16_f32 v32, v56, v57
    v_cvt_pk_bf16_f32 v33, v58, v59
    v_exp_f32 v60, v60
    v_exp_f32 v61, v61
    s_waitcnt lgkmcnt(1)
    v_mfma_f32_32x32x16_bf16 v[40:55], v[8:11], v[4:7], 0
    ds_read_b128 v[16:19], v88 offset:12672
    ds_read_b128 v[12:15], v3 offset:14784
    v_exp_f32 v62, v62
    v_exp_f32 v63, v63
    v_cvt_pk_bf16_f32 v34, v60, v61
    v_cvt_pk_bf16_f32 v35, v62, v63
    v_exp_f32 v64, v64
    v_exp_f32 v65, v65
    v_mfma_f32_32x32x16_bf16 v[72:87], v[24:27], v[32:35], v[72:87]
    v_exp_f32 v66, v66
    v_exp_f32 v67, v67
    v_exp_f32 v68, v68
    v_exp_f32 v69, v69
    v_exp_f32 v70, v70
    v_exp_f32 v71, v71
    v_cvt_pk_bf16_f32 v36, v64, v65
    v_cvt_pk_bf16_f32 v37, v66, v67
    v_cvt_pk_bf16_f32 v38, v68, v69
    v_cvt_pk_bf16_f32 v39, v70, v71
    v_exp_f32 v40, v40
    v_exp_f32 v41, v41
    v_mfma_f32_32x32x16_bf16 v[72:87], v[28:31], v[36:39], v[72:87]
    ds_read_b128 v[28:31], v88 offset:15328
    v_exp_f32 v42, v42
    v_exp_f32 v43, v43
    v_cvt_pk_bf16_f32 v32, v40, v41
    v_cvt_pk_bf16_f32 v33, v42, v43
    v_exp_f32 v44, v44
    v_exp_f32 v45, v45
    s_waitcnt lgkmcnt(1)
    v_mfma_f32_32x32x16_bf16 v[56:71], v[12:15], v[4:7], 0
    ds_read_b128 v[24:27], v88 offset:14784
    ds_read_b128 v[8:11], v3 offset:16896
    v_exp_f32 v46, v46
    v_exp_f32 v47, v47
    v_cvt_pk_bf16_f32 v34, v44, v45
    v_cvt_pk_bf16_f32 v35, v46, v47
    v_exp_f32 v48, v48
    v_exp_f32 v49, v49
    v_mfma_f32_32x32x16_bf16 v[72:87], v[16:19], v[32:35], v[72:87]
    v_exp_f32 v50, v50
    v_exp_f32 v51, v51
    v_exp_f32 v52, v52
    v_exp_f32 v53, v53
    v_exp_f32 v54, v54
    v_exp_f32 v55, v55
    v_cvt_pk_bf16_f32 v36, v48, v49
    v_cvt_pk_bf16_f32 v37, v50, v51
    v_cvt_pk_bf16_f32 v38, v52, v53
    v_cvt_pk_bf16_f32 v39, v54, v55
    v_exp_f32 v56, v56
    v_exp_f32 v57, v57
    v_mfma_f32_32x32x16_bf16 v[72:87], v[20:23], v[36:39], v[72:87]
    ds_read_b128 v[20:23], v88 offset:17440
    v_exp_f32 v58, v58
    v_exp_f32 v59, v59
    v_cvt_pk_bf16_f32 v32, v56, v57
    v_cvt_pk_bf16_f32 v33, v58, v59
    v_exp_f32 v60, v60
    v_exp_f32 v61, v61
    s_waitcnt lgkmcnt(1)
    v_mfma_f32_32x32x16_bf16 v[40:55], v[8:11], v[4:7], 0
    ds_read_b128 v[16:19], v88 offset:16896
    ds_read_b128 v[12:15], v3 offset:19008
    v_exp_f32 v62, v62
    v_exp_f32 v63, v63
    v_cvt_pk_bf16_f32 v34, v60, v61
    v_cvt_pk_bf16_f32 v35, v62, v63
    v_exp_f32 v64, v64
    v_exp_f32 v65, v65
    v_mfma_f32_32x32x16_bf16 v[72:87], v[24:27], v[32:35], v[72:87]
    v_exp_f32 v66, v66
    v_exp_f32 v67, v67
    v_exp_f32 v68, v68
    v_exp_f32 v69, v69
    v_exp_f32 v70, v70
    v_exp_f32 v71, v71
    v_cvt_pk_bf16_f32 v36, v64, v65
    v_cvt_pk_bf16_f32 v37, v66, v67
    v_cvt_pk_bf16_f32 v38, v68, v69
    v_cvt_pk_bf16_f32 v39, v70, v71
    v_exp_f32 v40, v40
    v_exp_f32 v41, v41
    v_mfma_f32_32x32x16_bf16 v[72:87], v[28:31], v[36:39], v[72:87]
    ds_read_b128 v[28:31], v88 offset:19552
    v_exp_f32 v42, v42
    v_exp_f32 v43, v43
    v_cvt_pk_bf16_f32 v32, v40, v41
    v_cvt_pk_bf16_f32 v33, v42, v43
    v_exp_f32 v44, v44
    v_exp_f32 v45, v45
    s_waitcnt lgkmcnt(1)
    v_mfma_f32_32x32x16_bf16 v[56:71], v[12:15], v[4:7], 0
    ds_read_b128 v[24:27], v88 offset:19008
    ds_read_b128 v[8:11], v3 offset:21120
    v_exp_f32 v46, v46
    v_exp_f32 v47, v47
    v_cvt_pk_bf16_f32 v34, v44, v45
    v_cvt_pk_bf16_f32 v35, v46, v47
    v_exp_f32 v48, v48
    v_exp_f32 v49, v49
    v_mfma_f32_32x32x16_bf16 v[72:87], v[16:19], v[32:35], v[72:87]
    v_exp_f32 v50, v50
    v_exp_f32 v51, v51
    v_exp_f32 v52, v52
    v_exp_f32 v53, v53
    v_exp_f32 v54, v54
    v_exp_f32 v55, v55
    v_cvt_pk_bf16_f32 v36, v48, v49
    v_cvt_pk_bf16_f32 v37, v50, v51
    v_cvt_pk_bf16_f32 v38, v52, v53
    v_cvt_pk_bf16_f32 v39, v54, v55
    v_exp_f32 v56, v56
    v_exp_f32 v57, v57
    v_mfma_f32_32x32x16_bf16 v[72:87], v[20:23], v[36:39], v[72:87]
    ds_read_b128 v[20:23], v88 offset:21664
    v_exp_f32 v58, v58
    v_exp_f32 v59, v59
    v_cvt_pk_bf16_f32 v32, v56, v57
    v_cvt_pk_bf16_f32 v33, v58, v59
    v_exp_f32 v60, v60
    v_exp_f32 v61, v61
    s_waitcnt lgkmcnt(1)
    v_mfma_f32_32x32x16_bf16 v[40:55], v[8:11], v[4:7], 0
    ds_read_b128 v[16:19], v88 offset:21120
    ds_read_b128 v[12:15], v3 offset:23232
    v_exp_f32 v62, v62
    v_exp_f32 v63, v63
    v_cvt_pk_bf16_f32 v34, v60, v61
    v_cvt_pk_bf16_f32 v35, v62, v63
    v_exp_f32 v64, v64
    v_exp_f32 v65, v65
    v_mfma_f32_32x32x16_bf16 v[72:87], v[24:27], v[32:35], v[72:87]
    v_exp_f32 v66, v66
    v_exp_f32 v67, v67
    v_exp_f32 v68, v68
    v_exp_f32 v69, v69
    v_exp_f32 v70, v70
    v_exp_f32 v71, v71
    v_cvt_pk_bf16_f32 v36, v64, v65
    v_cvt_pk_bf16_f32 v37, v66, v67
    v_cvt_pk_bf16_f32 v38, v68, v69
    v_cvt_pk_bf16_f32 v39, v70, v71
    s_waitcnt vmcnt(0)
    s_barrier
    s_cmp_lg_u32 s16, 0
    s_cbranch_scc1 L_w0_21
    v_mov_b32 v89, s62
    v_mov_b32 v91, 0
    s_lshl_b32 s21, s19, 7
    s_add_u32 s21, s21, 25362432
    s_mov_b64 exec, 1
    buffer_store_dword v89, v91, s[8:11], s21 offen sc1
    s_mov_b64 exec, -1
L_w0_21:
    v_exp_f32 v40, v40
    v_exp_f32 v41, v41
    v_mfma_f32_32x32x16_bf16 v[72:87], v[28:31], v[36:39], v[72:87]
    ds_read_b128 v[28:31], v88 offset:23776
    v_exp_f32 v42, v42
    v_exp_f32 v43, v43
    v_cvt_pk_bf16_f32 v32, v40, v41
    v_cvt_pk_bf16_f32 v33, v42, v43
    v_exp_f32 v44, v44
    v_exp_f32 v45, v45
    s_waitcnt lgkmcnt(1)
    v_mfma_f32_32x32x16_bf16 v[56:71], v[12:15], v[4:7], 0
    ds_read_b128 v[24:27], v88 offset:23232
    ds_read_b128 v[8:11], v3 offset:25344
    v_exp_f32 v46, v46
    v_exp_f32 v47, v47
    v_cvt_pk_bf16_f32 v34, v44, v45
    v_cvt_pk_bf16_f32 v35, v46, v47
    v_exp_f32 v48, v48
    v_exp_f32 v49, v49
    v_mfma_f32_32x32x16_bf16 v[72:87], v[16:19], v[32:35], v[72:87]
    v_exp_f32 v50, v50
    v_exp_f32 v51, v51
    v_exp_f32 v52, v52
    v_exp_f32 v53, v53
    v_exp_f32 v54, v54
    v_exp_f32 v55, v55
    v_cvt_pk_bf16_f32 v36, v48, v49
    v_cvt_pk_bf16_f32 v37, v50, v51
    v_cvt_pk_bf16_f32 v38, v52, v53
    v_cvt_pk_bf16_f32 v39, v54, v55
    v_exp_f32 v56, v56
    v_exp_f32 v57, v57
    v_mfma_f32_32x32x16_bf16 v[72:87], v[20:23], v[36:39], v[72:87]
    ds_read_b128 v[20:23], v88 offset:25888
    v_exp_f32 v58, v58
    v_exp_f32 v59, v59
    v_cvt_pk_bf16_f32 v32, v56, v57
    v_cvt_pk_bf16_f32 v33, v58, v59
    v_exp_f32 v60, v60
    v_exp_f32 v61, v61
    s_waitcnt lgkmcnt(1)
    v_mfma_f32_32x32x16_bf16 v[40:55], v[8:11], v[4:7], 0
    ds_read_b128 v[16:19], v88 offset:25344
    ds_read_b128 v[12:15], v3 offset:27456
    v_exp_f32 v62, v62
    v_exp_f32 v63, v63
    v_cvt_pk_bf16_f32 v34, v60, v61
    v_cvt_pk_bf16_f32 v35, v62, v63
    v_exp_f32 v64, v64
    v_exp_f32 v65, v65
    v_mfma_f32_32x32x16_bf16 v[72:87], v[24:27], v[32:35], v[72:87]
    v_exp_f32 v66, v66
    v_exp_f32 v67, v67
    v_exp_f32 v68, v68
    v_exp_f32 v69, v69
    v_exp_f32 v70, v70
    v_exp_f32 v71, v71
    v_cvt_pk_bf16_f32 v36, v64, v65
    v_cvt_pk_bf16_f32 v37, v66, v67
    v_cvt_pk_bf16_f32 v38, v68, v69
    v_cvt_pk_bf16_f32 v39, v70, v71
    v_exp_f32 v40, v40
    v_exp_f32 v41, v41
    v_mfma_f32_32x32x16_bf16 v[72:87], v[28:31], v[36:39], v[72:87]
    ds_read_b128 v[28:31], v88 offset:28000
    v_exp_f32 v42, v42
    v_exp_f32 v43, v43
    v_cvt_pk_bf16_f32 v32, v40, v41
    v_cvt_pk_bf16_f32 v33, v42, v43
    v_exp_f32 v44, v44
    v_exp_f32 v45, v45
    s_waitcnt lgkmcnt(1)
    v_mfma_f32_32x32x16_bf16 v[56:71], v[12:15], v[4:7], 0
    ds_read_b128 v[24:27], v88 offset:27456
    ds_read_b128 v[8:11], v3 offset:29568
    v_exp_f32 v46, v46
    v_exp_f32 v47, v47
    v_cvt_pk_bf16_f32 v34, v44, v45
    v_cvt_pk_bf16_f32 v35, v46, v47
    v_exp_f32 v48, v48
    v_exp_f32 v49, v49
    v_mfma_f32_32x32x16_bf16 v[72:87], v[16:19], v[32:35], v[72:87]
    v_exp_f32 v50, v50
    v_exp_f32 v51, v51
    v_exp_f32 v52, v52
    v_exp_f32 v53, v53
    v_exp_f32 v54, v54
    v_exp_f32 v55, v55
    v_cvt_pk_bf16_f32 v36, v48, v49
    v_cvt_pk_bf16_f32 v37, v50, v51
    v_cvt_pk_bf16_f32 v38, v52, v53
    v_cvt_pk_bf16_f32 v39, v54, v55
    v_exp_f32 v56, v56
    v_exp_f32 v57, v57
    v_mfma_f32_32x32x16_bf16 v[72:87], v[20:23], v[36:39], v[72:87]
    ds_read_b128 v[20:23], v88 offset:30112
    v_exp_f32 v58, v58
    v_exp_f32 v59, v59
    v_cvt_pk_bf16_f32 v32, v56, v57
    v_cvt_pk_bf16_f32 v33, v58, v59
    v_exp_f32 v60, v60
    v_exp_f32 v61, v61
    s_waitcnt lgkmcnt(1)
    v_mfma_f32_32x32x16_bf16 v[40:55], v[8:11], v[4:7], 0
    ds_read_b128 v[16:19], v88 offset:29568
    ds_read_b128 v[12:15], v3 offset:31680
    v_exp_f32 v62, v62
    v_exp_f32 v63, v63
    v_cvt_pk_bf16_f32 v34, v60, v61
    v_cvt_pk_bf16_f32 v35, v62, v63
    v_exp_f32 v64, v64
    v_exp_f32 v65, v65
    v_mfma_f32_32x32x16_bf16 v[72:87], v[24:27], v[32:35], v[72:87]
    v_exp_f32 v66, v66
    v_exp_f32 v67, v67
    v_exp_f32 v68, v68
    v_exp_f32 v69, v69
    v_exp_f32 v70, v70
    v_exp_f32 v71, v71
    v_cvt_pk_bf16_f32 v36, v64, v65
    v_cvt_pk_bf16_f32 v37, v66, v67
    v_cvt_pk_bf16_f32 v38, v68, v69
    v_cvt_pk_bf16_f32 v39, v70, v71
    s_cmp_lg_u32 s16, 7
    s_cbranch_scc1 L_w0_22
    v_lshlrev_b32 v89, 7, v1
    s_mov_b32 s21, 25362432
    s_add_u32 s23, s21, 0
    buffer_load_dword v92, v89, s[8:11], s23 offen sc1
    s_add_u32 s23, s21, 8192
    buffer_load_dword v93, v89, s[8:11], s23 offen sc1
    s_add_u32 s23, s21, 16384
    buffer_load_dword v94, v89, s[8:11], s23 offen sc1
    s_add_u32 s23, s21, 24576
    buffer_load_dword v95, v89, s[8:11], s23 offen sc1
L_w0_22:
    v_exp_f32 v40, v40
    v_exp_f32 v41, v41
    v_mfma_f32_32x32x16_bf16 v[72:87], v[28:31], v[36:39], v[72:87]
    ds_read_b128 v[28:31], v88 offset:32224
    v_exp_f32 v42, v42
    v_exp_f32 v43, v43
    v_cvt_pk_bf16_f32 v32, v40, v41
    v_cvt_pk_bf16_f32 v33, v42, v43
    v_exp_f32 v44, v44
    v_exp_f32 v45, v45
    s_waitcnt lgkmcnt(1)
    v_mfma_f32_32x32x16_bf16 v[56:71], v[12:15], v[4:7], 0
    ds_read_b128 v[24:27], v88 offset:31680
    ds_read_b128 v[8:11], v3 offset:33792
    v_exp_f32 v46, v46
    v_exp_f32 v47, v47
    v_cvt_pk_bf16_f32 v34, v44, v45
    v_cvt_pk_bf16_f32 v35, v46, v47
    v_exp_f32 v48, v48
    v_exp_f32 v49, v49
    v_mfma_f32_32x32x16_bf16 v[72:87], v[16:19], v[32:35], v[72:87]
    v_exp_f32 v50, v50
    v_exp_f32 v51, v51
    v_exp_f32 v52, v52
    v_exp_f32 v53, v53
    v_exp_f32 v54, v54
    v_exp_f32 v55, v55
    v_cvt_pk_bf16_f32 v36, v48, v49
    v_cvt_pk_bf16_f32 v37, v50, v51
    v_cvt_pk_bf16_f32 v38, v52, v53
    v_cvt_pk_bf16_f32 v39, v54, v55
    v_exp_f32 v56, v56
    v_exp_f32 v57, v57
    v_mfma_f32_32x32x16_bf16 v[72:87], v[20:23], v[36:39], v[72:87]
    ds_read_b128 v[20:23], v88 offset:34336
    v_exp_f32 v58, v58
    v_exp_f32 v59, v59
    v_cvt_pk_bf16_f32 v32, v56, v57
    v_cvt_pk_bf16_f32 v33, v58, v59
    v_exp_f32 v60, v60
    v_exp_f32 v61, v61
    s_waitcnt lgkmcnt(1)
    v_mfma_f32_32x32x16_bf16 v[40:55], v[8:11], v[4:7], 0
    ds_read_b128 v[16:19], v88 offset:33792
    ds_read_b128 v[12:15], v3 offset:35904
    v_exp_f32 v62, v62
    v_exp_f32 v63, v63
    v_cvt_pk_bf16_f32 v34, v60, v61
    v_cvt_pk_bf16_f32 v35, v62, v63
    v_exp_f32 v64, v64
    v_exp_f32 v65, v65
    v_mfma_f32_32x32x16_bf16 v[72:87], v[24:27], v[32:35], v[72:87]
    v_exp_f32 v66, v66
    v_exp_f32 v67, v67
    v_exp_f32 v68, v68
    v_exp_f32 v69, v69
    v_exp_f32 v70, v70
    v_exp_f32 v71, v71
    v_cvt_pk_bf16_f32 v36, v64, v65
    v_cvt_pk_bf16_f32 v37, v66, v67
    v_cvt_pk_bf16_f32 v38, v68, v69
    v_cvt_pk_bf16_f32 v39, v70, v71
    s_nop 1
    v_mfma_f32_32x32x16_bf16 v[72:87], v[28:31], v[36:39], v[72:87]
    s_mul_i32 s21, s16, 3072
    s_add_u32 s21, s21, 139264
    v_add_u32 v56, s21, v2
    s_xor_b32 s22, s16, 4
    s_mul_i32 s22, s22, 3072
    s_add_u32 s22, s22, 139264
    v_add_u32 v57, s22, v2
    s_nop 7
    s_cmp_ge_u32 s16, 4
    s_cbranch_scc0 L_xw_23
    ds_write_b128 v56, v[72:75] offset:0
    ds_write_b128 v56, v[76:79] offset:1024
    ds_write_b128 v56, v[80:83] offset:2048
L_xw_23:
    s_waitcnt lgkmcnt(0)
    s_barrier
    s_cmp_ge_u32 s16, 4
    s_cbranch_scc1 L_fa_24
    ds_read_b128 v[44:47], v57 offset:0
    ds_read_b128 v[48:51], v57 offset:1024
    ds_read_b128 v[52:55], v57 offset:2048
    s_waitcnt lgkmcnt(0)
    v_add_f32 v72, v72, v44
    v_add_f32 v73, v73, v45
    v_add_f32 v74, v74, v46
    v_add_f32 v75, v75, v47
    v_add_f32 v76, v76, v48
    v_add_f32 v77, v77, v49
    v_add_f32 v78, v78, v50
    v_add_f32 v79, v79, v51
    v_add_f32 v80, v80, v52
    v_rcp_f32 v80, v80
    s_nop 0
    v_mul_f32 v72, v72, v80
    v_mul_f32 v73, v73, v80
    v_mul_f32 v74, v74, v80
    v_mul_f32 v75, v75, v80
    v_mul_f32 v76, v76, v80
    v_mul_f32 v77, v77, v80
    v_mul_f32 v78, v78, v80
    v_mul_f32 v79, v79, v80
    v_cvt_pk_bf16_f32 v40, v72, v73
    v_cvt_pk_bf16_f32 v41, v74, v75
    v_cvt_pk_bf16_f32 v42, v76, v77
    v_cvt_pk_bf16_f32 v43, v78, v79
    s_add_u32 s21, s20, 0
    buffer_store_dwordx4 v[40:43], v2, s[8:11], s21 offen sc1
L_fa_24:
    v_mov_b32 v4, v252
    v_mov_b32 v5, v253
    v_mov_b32 v6, v254
    v_mov_b32 v7, v255
    v_add_u32 v3, s55, v2
    v_add_u32 v88, s55, v90
    ds_read_b128 v[8:11], v3 offset:0
    ds_read_b128 v[16:19], v88 offset:0
    ds_read_b128 v[20:23], v88 offset:544
    ds_read_b128 v[12:15], v3 offset:2112
    v_mov_b32 v72, 0
    v_mov_b32 v73, 0
    v_mov_b32 v74, 0
    v_mov_b32 v75, 0
    v_mov_b32 v76, 0
    v_mov_b32 v77, 0
    v_mov_b32 v78, 0
    v_mov_b32 v79, 0
    v_mov_b32 v80, 0
    v_mov_b32 v81, 0
    v_mov_b32 v82, 0
    v_mov_b32 v83, 0
    v_mov_b32 v84, 0
    v_mov_b32 v85, 0
    v_mov_b32 v86, 0
    v_mov_b32 v87, 0
    v_mov_b32 v36, 0
    v_mov_b32 v28, 0
    v_mov_b32 v37, 0
    v_mov_b32 v29, 0
    v_mov_b32 v38, 0
    v_mov_b32 v30, 0
    v_mov_b32 v39, 0
    v_mov_b32 v31, 0
    s_waitcnt lgkmcnt(0)
    v_mfma_f32_32x32x16_bf16 v[40:55], v[8:11], v[4:7], 0
    s_nop 15
    v_exp_f32 v40, v40
    v_exp_f32 v41, v41
    v_mfma_f32_32x32x16_bf16 v[72:87], v[28:31], v[36:39], v[72:87]
    ds_read_b128 v[28:31], v88 offset:2656
    v_exp_f32 v42, v42
    v_exp_f32 v43, v43
    v_cvt_pk_bf16_f32 v32, v40, v41
    v_cvt_pk_bf16_f32 v33, v42, v43
    v_exp_f32 v44, v44
    v_exp_f32 v45, v45
    s_waitcnt lgkmcnt(1)
    v_mfma_f32_32x32x16_bf16 v[56:71], v[12:15], v[4:7], 0
    ds_read_b128 v[24:27], v88 offset:2112
    ds_read_b128 v[8:11], v3 offset:4224
    v_exp_f32 v46, v46
    v_exp_f32 v47, v47
    v_cvt_pk_bf16_f32 v34, v44, v45
    v_cvt_pk_bf16_f32 v35, v46, v47
    v_exp_f32 v48, v48
    v_exp_f32 v49, v49
    v_mfma_f32_32x32x16_bf16 v[72:87], v[16:19], v[32:35], v[72:87]
    v_exp_f32 v50, v50
    v_exp_f32 v51, v51
    v_exp_f32 v52, v52
    v_exp_f32 v53, v53
    v_exp_f32 v54, v54
    v_exp_f32 v55, v55
    v_cvt_pk_bf16_f32 v36, v48, v49
    v_cvt_pk_bf16_f32 v37, v50, v51
    v_cvt_pk_bf16_f32 v38, v52, v53
    v_cvt_pk_bf16_f32 v39, v54, v55
    s_cmp_lg_u32 s16, 7
    s_cbranch_scc1 L_w0_25
    s_mov_b32 s22, 0
L_pp_26:
    s_add_u32 s22, s22, 1
    s_waitcnt vmcnt(0)
    v_xor_b32 v92, s62, v92
    v_xor_b32 v93, s62, v93
    v_xor_b32 v94, s62, v94
    v_xor_b32 v95, s62, v95
    v_or3_b32 v92, v92, v93, v94
    v_or_b32 v92, v92, v95
    v_cmp_ne_u32 vcc, 0, v92
    s_cmp_gt_u32 s22, 200000
    s_cbranch_scc1 L_pd_27
    s_cbranch_vccz L_pd_27
    v_lshlrev_b32 v89, 7, v1
    s_mov_b32 s21, 25362432
    s_add_u32 s23, s21, 0
    buffer_load_dword v92, v89, s[8:11], s23 offen sc1
    s_add_u32 s23, s21, 8192
    buffer_load_dword v93, v89, s[8:11], s23 offen sc1
    s_add_u32 s23, s21, 16384
    buffer_load_dword v94, v89, s[8:11], s23 offen sc1
    s_add_u32 s23, s21, 24576
    buffer_load_dword v95, v89, s[8:11], s23 offen sc1
    s_branch L_pp_26
L_pd_27:
L_w0_25:
    s_barrier
    v_exp_f32 v56, v56
    v_exp_f32 v57, v57
    v_mfma_f32_32x32x16_bf16 v[72:87], v[20:23], v[36:39], v[72:87]
    ds_read_b128 v[20:23], v88 offset:4768
    v_exp_f32 v58, v58
    v_exp_f32 v59, v59
    v_cvt_pk_bf16_f32 v32, v56, v57
    v_cvt_pk_bf16_f32 v33, v58, v59
    v_exp_f32 v60, v60
    v_exp_f32 v61, v61
    s_waitcnt lgkmcnt(1)
    v_mfma_f32_32x32x16_bf16 v[40:55], v[8:11], v[4:7], 0
    ds_read_b128 v[16:19], v88 offset:4224
    ds_read_b128 v[12:15], v3 offset:6336
    buffer_load_dwordx4 v[96:99], v2, s[8:11], s34 offen offset:0 sc1
    buffer_load_dwordx4 v[100:103], v2, s[8:11], s35 offen offset:0 sc1
    v_exp_f32 v62, v62
    v_exp_f32 v63, v63
    v_cvt_pk_bf16_f32 v34, v60, v61
    v_cvt_pk_bf16_f32 v35, v62, v63
    v_exp_f32 v64, v64
    v_exp_f32 v65, v65
    v_mfma_f32_32x32x16_bf16 v[72:87], v[24:27], v[32:35], v[72:87]
    v_exp_f32 v66, v66
    v_exp_f32 v67, v67
    v_exp_f32 v68, v68
    v_exp_f32 v69, v69
    v_exp_f32 v70, v70
    v_exp_f32 v71, v71
    v_cvt_pk_bf16_f32 v36, v64, v65
    v_cvt_pk_bf16_f32 v37, v66, v67
    v_cvt_pk_bf16_f32 v38, v68, v69
    v_cvt_pk_bf16_f32 v39, v70, v71
    v_exp_f32 v40, v40
    v_exp_f32 v41, v41
    v_mfma_f32_32x32x16_bf16 v[72:87], v[28:31], v[36:39], v[72:87]
    ds_read_b128 v[28:31], v88 offset:6880
    v_exp_f32 v42, v42
    v_exp_f32 v43, v43
    v_cvt_pk_bf16_f32 v32, v40, v41
    v_cvt_pk_bf16_f32 v33, v42, v43
    v_exp_f32 v44, v44
    v_exp_f32 v45, v45
    s_waitcnt lgkmcnt(1)
    v_mfma_f32_32x32x16_bf16 v[56:71], v[12:15], v[4:7], 0
    ds_read_b128 v[24:27], v88 offset:6336
    ds_read_b128 v[8:11], v3 offset:8448
    buffer_load_dwordx4 v[104:107], v2, s[8:11], s34 offen offset:1024 sc1
    buffer_load_dwordx4 v[108:111], v2, s[8:11], s35 offen offset:1024 sc1
    v_exp_f32 v46, v46
    v_exp_f32 v47, v47
    v_cvt_pk_bf16_f32 v34, v44, v45
    v_cvt_pk_bf16_f32 v35, v46, v47
    v_exp_f32 v48, v48
    v_exp_f32 v49, v49
    v_mfma_f32_32x32x16_bf16 v[72:87], v[16:19], v[32:35], v[72:87]
    v_exp_f32 v50, v50
    v_exp_f32 v51, v51
    v_exp_f32 v52, v52
    v_exp_f32 v53, v53
    v_exp_f32 v54, v54
    v_exp_f32 v55, v55
    v_cvt_pk_bf16_f32 v36, v48, v49
    v_cvt_pk_bf16_f32 v37, v50, v51
    v_cvt_pk_bf16_f32 v38, v52, v53
    v_cvt_pk_bf16_f32 v39, v54, v55
    v_exp_f32 v56, v56
    v_exp_f32 v57, v57
    v_mfma_f32_32x32x16_bf16 v[72:87], v[20:23], v[36:39], v[72:87]
    ds_read_b128 v[20:23], v88 offset:8992
    v_exp_f32 v58, v58
    v_exp_f32 v59, v59
    v_cvt_pk_bf16_f32 v32, v56, v57
    v_cvt_pk_bf16_f32 v33, v58, v59
    v_exp_f32 v60, v60
    v_exp_f32 v61, v61
    s_waitcnt lgkmcnt(1)
    v_mfma_f32_32x32x16_bf16 v[40:55], v[8:11], v[4:7], 0
    ds_read_b128 v[16:19], v88 offset:8448
    ds_read_b128 v[12:15], v3 offset:10560
    buffer_load_dwordx4 v[112:115], v2, s[8:11], s34 offen offset:2048 sc1
    buffer_load_dwordx4 v[116:119], v2, s[8:11], s35 offen offset:2048 sc1
    v_exp_f32 v62, v62
    v_exp_f32 v63, v63
    v_cvt_pk_bf16_f32 v34, v60, v61
    v_cvt_pk_bf16_f32 v35, v62, v63
    v_exp_f32 v64, v64
    v_exp_f32 v65, v65
    v_mfma_f32_32x32x16_bf16 v[72:87], v[24:27], v[32:35], v[72:87]
    v_exp_f32 v66, v66
    v_exp_f32 v67, v67
    v_exp_f32 v68, v68
    v_exp_f32 v69, v69
    v_exp_f32 v70, v70
    v_exp_f32 v71, v71
    v_cvt_pk_bf16_f32 v36, v64, v65
    v_cvt_pk_bf16_f32 v37, v66, v67
    v_cvt_pk_bf16_f32 v38, v68, v69
    v_cvt_pk_bf16_f32 v39, v70, v71
    v_exp_f32 v40, v40
    v_exp_f32 v41, v41
    v_mfma_f32_32x32x16_bf16 v[72:87], v[28:31], v[36:39], v[72:87]
    ds_read_b128 v[28:31], v88 offset:11104
    v_exp_f32 v42, v42
    v_exp_f32 v43, v43
    v_cvt_pk_bf16_f32 v32, v40, v41
    v_cvt_pk_bf16_f32 v33, v42, v43
    v_exp_f32 v44, v44
    v_exp_f32 v45, v45
    s_waitcnt lgkmcnt(1)
    v_mfma_f32_32x32x16_bf16 v[56:71], v[12:15], v[4:7], 0
    ds_read_b128 v[24:27], v88 offset:10560
    ds_read_b128 v[8:11], v3 offset:12672
    buffer_load_dwordx4 v[120:123], v2, s[8:11], s34 offen offset:3072 sc1
    s_add_u32 s34, s34, 4096
    buffer_load_dwordx4 v[124:127], v2, s[8:11], s35 offen offset:3072 sc1
    s_add_u32 s35, s35, 4096
    v_exp_f32 v46, v46
    v_exp_f32 v47, v47
    v_cvt_pk_bf16_f32 v34, v44, v45
    v_cvt_pk_bf16_f32 v35, v46, v47
    v_exp_f32 v48, v48
    v_exp_f32 v49, v49
    v_mfma_f32_32x32x16_bf16 v[72:87], v[16:19], v[32:35], v[72:87]
    v_exp_f32 v50, v50
    v_exp_f32 v51, v51
    v_exp_f32 v52, v52
    v_exp_f32 v53, v53
    v_exp_f32 v54, v54
    v_exp_f32 v55, v55
    v_cvt_pk_bf16_f32 v36, v48, v49
    v_cvt_pk_bf16_f32 v37, v50, v51
    v_cvt_pk_bf16_f32 v38, v52, v53
    v_cvt_pk_bf16_f32 v39, v54, v55
    s_waitcnt vmcnt(8)
    s_barrier
    s_cmp_lg_u32 s16, 0
    s_cbranch_scc1 L_w0_28
    v_mov_b32 v89, s62
    v_mov_b32 v91, 0
    s_lshl_b32 s21, s19, 7
    s_add_u32 s21, s21, 25165824
    s_mov_b64 exec, 1
    buffer_store_dword v89, v91, s[8:11], s21 offen sc1
    s_mov_b64 exec, -1
L_w0_28:
    v_exp_f32 v56, v56
    v_exp_f32 v57, v57
    v_mfma_f32_32x32x16_bf16 v[72:87], v[20:23], v[36:39], v[72:87]
    ds_read_b128 v[20:23], v88 offset:13216
    v_exp_f32 v58, v58
    v_exp_f32 v59, v59
    v_cvt_pk_bf16_f32 v32, v56, v57
    v_cvt_pk_bf16_f32 v33, v58, v59
    v_exp_f32 v60, v60
    v_exp_f32 v61, v61
    s_waitcnt lgkmcnt(1)
    v_mfma_f32_32x32x16_bf16 v[40:55], v[8:11], v[4:7], 0
    ds_read_b128 v[16:19], v88 offset:12672
    ds_read_b128 v[12:15], v3 offset:14784
    buffer_load_dwordx4 v[128:131], v2, s[8:11], s34 offen offset:0 sc1
    buffer_load_dwordx4 v[132:135], v2, s[8:11], s35 offen offset:0 sc1
    v_exp_f32 v62, v62
    v_exp_f32 v63, v63
    v_cvt_pk_bf16_f32 v34, v60, v61
    v_cvt_pk_bf16_f32 v35, v62, v63
    v_exp_f32 v64, v64
    v_exp_f32 v65, v65
    v_mfma_f32_32x32x16_bf16 v[72:87], v[24:27], v[32:35], v[72:87]
    v_exp_f32 v66, v66
    v_exp_f32 v67, v67
    v_exp_f32 v68, v68
    v_exp_f32 v69, v69
    v_exp_f32 v70, v70
    v_exp_f32 v71, v71
    v_cvt_pk_bf16_f32 v36, v64, v65
    v_cvt_pk_bf16_f32 v37, v66, v67
    v_cvt_pk_bf16_f32 v38, v68, v69
    v_cvt_pk_bf16_f32 v39, v70, v71
    v_exp_f32 v40, v40
    v_exp_f32 v41, v41
    v_mfma_f32_32x32x16_bf16 v[72:87], v[28:31], v[36:39], v[72:87]
    ds_read_b128 v[28:31], v88 offset:15328
    v_exp_f32 v42, v42
    v_exp_f32 v43, v43
    v_cvt_pk_bf16_f32 v32, v40, v41
    v_cvt_pk_bf16_f32 v33, v42, v43
    v_exp_f32 v44, v44
    v_exp_f32 v45, v45
    s_waitcnt lgkmcnt(1)
    v_mfma_f32_32x32x16_bf16 v[56:71], v[12:15], v[4:7], 0
    ds_read_b128 v[24:27], v88 offset:14784
    ds_read_b128 v[8:11], v3 offset:16896
    buffer_load_dwordx4 v[136:139], v2, s[8:11], s34 offen offset:1024 sc1
    buffer_load_dwordx4 v[140:143], v2, s[8:11], s35 offen offset:1024 sc1
    v_exp_f32 v46, v46
    v_exp_f32 v47, v47
    v_cvt_pk_bf16_f32 v34, v44, v45
    v_cvt_pk_bf16_f32 v35, v46, v47
    v_exp_f32 v48, v48
    v_exp_f32 v49, v49
    v_mfma_f32_32x32x16_bf16 v[72:87], v[16:19], v[32:35], v[72:87]
    v_exp_f32 v50, v50
    v_exp_f32 v51, v51
    v_exp_f32 v52, v52
    v_exp_f32 v53, v53
    v_exp_f32 v54, v54
    v_exp_f32 v55, v55
    v_cvt_pk_bf16_f32 v36, v48, v49
    v_cvt_pk_bf16_f32 v37, v50, v51
    v_cvt_pk_bf16_f32 v38, v52, v53
    v_cvt_pk_bf16_f32 v39, v54, v55
    v_exp_f32 v56, v56
    v_exp_f32 v57, v57
    v_mfma_f32_32x32x16_bf16 v[72:87], v[20:23], v[36:39], v[72:87]
    ds_read_b128 v[20:23], v88 offset:17440
    v_exp_f32 v58, v58
    v_exp_f32 v59, v59
    v_cvt_pk_bf16_f32 v32, v56, v57
    v_cvt_pk_bf16_f32 v33, v58, v59
    v_exp_f32 v60, v60
    v_exp_f32 v61, v61
    s_waitcnt lgkmcnt(1)
    v_mfma_f32_32x32x16_bf16 v[40:55], v[8:11], v[4:7], 0
    ds_read_b128 v[16:19], v88 offset:16896
    ds_read_b128 v[12:15], v3 offset:19008
    buffer_load_dwordx4 v[144:147], v2, s[8:11], s34 offen offset:2048 sc1
    buffer_load_dwordx4 v[148:151], v2, s[8:11], s35 offen offset:2048 sc1
    v_exp_f32 v62, v62
    v_exp_f32 v63, v63
    v_cvt_pk_bf16_f32 v34, v60, v61
    v_cvt_pk_bf16_f32 v35, v62, v63
    v_exp_f32 v64, v64
    v_exp_f32 v65, v65
    v_mfma_f32_32x32x16_bf16 v[72:87], v[24:27], v[32:35], v[72:87]
    v_exp_f32 v66, v66
    v_exp_f32 v67, v67
    v_exp_f32 v68, v68
    v_exp_f32 v69, v69
    v_exp_f32 v70, v70
    v_exp_f32 v71, v71
    v_cvt_pk_bf16_f32 v36, v64, v65
    v_cvt_pk_bf16_f32 v37, v66, v67
    v_cvt_pk_bf16_f32 v38, v68, v69
    v_cvt_pk_bf16_f32 v39, v70, v71
    v_exp_f32 v40, v40
    v_exp_f32 v41, v41
    v_mfma_f32_32x32x16_bf16 v[72:87], v[28:31], v[36:39], v[72:87]
    ds_read_b128 v[28:31], v88 offset:19552
    v_exp_f32 v42, v42
    v_exp_f32 v43, v43
    v_cvt_pk_bf16_f32 v32, v40, v41
    v_cvt_pk_bf16_f32 v33, v42, v43
    v_exp_f32 v44, v44
    v_exp_f32 v45, v45
    s_waitcnt lgkmcnt(1)
    v_mfma_f32_32x32x16_bf16 v[56:71], v[12:15], v[4:7], 0
    ds_read_b128 v[24:27], v88 offset:19008
    ds_read_b128 v[8:11], v3 offset:21120
    buffer_load_dwordx4 v[152:155], v2, s[8:11], s34 offen offset:3072 sc1
    s_add_u32 s34, s34, 4096
    buffer_load_dwordx4 v[156:159], v2, s[8:11], s35 offen offset:3072 sc1
    s_add_u32 s35, s35, 4096
    v_exp_f32 v46, v46
    v_exp_f32 v47, v47
    v_cvt_pk_bf16_f32 v34, v44, v45
    v_cvt_pk_bf16_f32 v35, v46, v47
    v_exp_f32 v48, v48
    v_exp_f32 v49, v49
    v_mfma_f32_32x32x16_bf16 v[72:87], v[16:19], v[32:35], v[72:87]
    v_exp_f32 v50, v50
    v_exp_f32 v51, v51
    v_exp_f32 v52, v52
    v_exp_f32 v53, v53
    v_exp_f32 v54, v54
    v_exp_f32 v55, v55
    v_cvt_pk_bf16_f32 v36, v48, v49
    v_cvt_pk_bf16_f32 v37, v50, v51
    v_cvt_pk_bf16_f32 v38, v52, v53
    v_cvt_pk_bf16_f32 v39, v54, v55
    v_exp_f32 v56, v56
    v_exp_f32 v57, v57
    v_mfma_f32_32x32x16_bf16 v[72:87], v[20:23], v[36:39], v[72:87]
    ds_read_b128 v[20:23], v88 offset:21664
    v_exp_f32 v58, v58
    v_exp_f32 v59, v59
    v_cvt_pk_bf16_f32 v32, v56, v57
    v_cvt_pk_bf16_f32 v33, v58, v59
    v_exp_f32 v60, v60
    v_exp_f32 v61, v61
    s_waitcnt lgkmcnt(1)
    v_mfma_f32_32x32x16_bf16 v[40:55], v[8:11], v[4:7], 0
    ds_read_b128 v[16:19], v88 offset:21120
    ds_read_b128 v[12:15], v3 offset:23232
    buffer_load_dwordx4 v[160:163], v2, s[8:11], s34 offen offset:0 sc1
    buffer_load_dwordx4 v[164:167], v2, s[8:11], s35 offen offset:0 sc1
    v_exp_f32 v62, v62
    v_exp_f32 v63, v63
    v_cvt_pk_bf16_f32 v34, v60, v61
    v_cvt_pk_bf16_f32 v35, v62, v63
    v_exp_f32 v64, v64
    v_exp_f32 v65, v65
    v_mfma_f32_32x32x16_bf16 v[72:87], v[24:27], v[32:35], v[72:87]
    v_exp_f32 v66, v66
    v_exp_f32 v67, v67
    v_exp_f32 v68, v68
    v_exp_f32 v69, v69
    v_exp_f32 v70, v70
    v_exp_f32 v71, v71
    v_cvt_pk_bf16_f32 v36, v64, v65
    v_cvt_pk_bf16_f32 v37, v66, v67
    v_cvt_pk_bf16_f32 v38, v68, v69
    v_cvt_pk_bf16_f32 v39, v70, v71
    v_exp_f32 v40, v40
    v_exp_f32 v41, v41
    v_mfma_f32_32x32x16_bf16 v[72:87], v[28:31], v[36:39], v[72:87]
    ds_read_b128 v[28:31], v88 offset:23776
    v_exp_f32 v42, v42
    v_exp_f32 v43, v43
    v_cvt_pk_bf16_f32 v32, v40, v41
    v_cvt_pk_bf16_f32 v33, v42, v43
    v_exp_f32 v44, v44
    v_exp_f32 v45, v45
    s_waitcnt lgkmcnt(1)
    v_mfma_f32_32x32x16_bf16 v[56:71], v[12:15], v[4:7], 0
    ds_read_b128 v[24:27], v88 offset:23232
    ds_read_b128 v[8:11], v3 offset:25344
    buffer_load_dwordx4 v[168:171], v2, s[8:11], s34 offen offset:1024 sc1
    buffer_load_dwordx4 v[172:175], v2, s[8:11], s35 offen offset:1024 sc1
    v_exp_f32 v46, v46
    v_exp_f32 v47, v47
    v_cvt_pk_bf16_f32 v34, v44, v45
    v_cvt_pk_bf16_f32 v35, v46, v47
    v_exp_f32 v48, v48
    v_exp_f32 v49, v49
    v_mfma_f32_32x32x16_bf16 v[72:87], v[16:19], v[32:35], v[72:87]
    v_exp_f32 v50, v50
    v_exp_f32 v51, v51
    v_exp_f32 v52, v52
    v_exp_f32 v53, v53
    v_exp_f32 v54, v54
    v_exp_f32 v55, v55
    v_cvt_pk_bf16_f32 v36, v48, v49
    v_cvt_pk_bf16_f32 v37, v50, v51
    v_cvt_pk_bf16_f32 v38, v52, v53
    v_cvt_pk_bf16_f32 v39, v54, v55
    v_exp_f32 v56, v56
    v_exp_f32 v57, v57
    v_mfma_f32_32x32x16_bf16 v[72:87], v[20:23], v[36:39], v[72:87]
    ds_read_b128 v[20:23], v88 offset:25888
    v_exp_f32 v58, v58
    v_exp_f32 v59, v59
    v_cvt_pk_bf16_f32 v32, v56, v57
    v_cvt_pk_bf16_f32 v33, v58, v59
    v_exp_f32 v60, v60
    v_exp_f32 v61, v61
    s_waitcnt lgkmcnt(1)
    v_mfma_f32_32x32x16_bf16 v[40:55], v[8:11], v[4:7], 0
    ds_read_b128 v[16:19], v88 offset:25344
    ds_read_b128 v[12:15], v3 offset:27456
    buffer_load_dwordx4 v[176:179], v2, s[8:11], s34 offen offset:2048 sc1
    buffer_load_dwordx4 v[180:183], v2, s[8:11], s35 offen offset:2048 sc1
    v_exp_f32 v62, v62
    v_exp_f32 v63, v63
    v_cvt_pk_bf16_f32 v34, v60, v61
    v_cvt_pk_bf16_f32 v35, v62, v63
    v_exp_f32 v64, v64
    v_exp_f32 v65, v65
    v_mfma_f32_32x32x16_bf16 v[72:87], v[24:27], v[32:35], v[72:87]
    v_exp_f32 v66, v66
    v_exp_f32 v67, v67
    v_exp_f32 v68, v68
    v_exp_f32 v69, v69
    v_exp_f32 v70, v70
    v_exp_f32 v71, v71
    v_cvt_pk_bf16_f32 v36, v64, v65
    v_cvt_pk_bf16_f32 v37, v66, v67
    v_cvt_pk_bf16_f32 v38, v68, v69
    v_cvt_pk_bf16_f32 v39, v70, v71
    v_exp_f32 v40, v40
    v_exp_f32 v41, v41
    v_mfma_f32_32x32x16_bf16 v[72:87], v[28:31], v[36:39], v[72:87]
    ds_read_b128 v[28:31], v88 offset:28000
    v_exp_f32 v42, v42
    v_exp_f32 v43, v43
    v_cvt_pk_bf16_f32 v32, v40, v41
    v_cvt_pk_bf16_f32 v33, v42, v43
    v_exp_f32 v44, v44
    v_exp_f32 v45, v45
    s_waitcnt lgkmcnt(1)
    v_mfma_f32_32x32x16_bf16 v[56:71], v[12:15], v[4:7], 0
    ds_read_b128 v[24:27], v88 offset:27456
    ds_read_b128 v[8:11], v3 offset:29568
    buffer_load_dwordx4 v[184:187], v2, s[8:11], s34 offen offset:3072 sc1
    s_add_u32 s34, s34, 4096
    v_exp_f32 v46, v46
    v_exp_f32 v47, v47
    v_cvt_pk_bf16_f32 v34, v44, v45
    v_cvt_pk_bf16_f32 v35, v46, v47
    v_exp_f32 v48, v48
    v_exp_f32 v49, v49
    v_mfma_f32_32x32x16_bf16 v[72:87], v[16:19], v[32:35], v[72:87]
    v_exp_f32 v50, v50
    v_exp_f32 v51, v51
    v_exp_f32 v52, v52
    v_exp_f32 v53, v53
    v_exp_f32 v54, v54
    v_exp_f32 v55, v55
    v_cvt_pk_bf16_f32 v36, v48, v49
    v_cvt_pk_bf16_f32 v37, v50, v51
    v_cvt_pk_bf16_f32 v38, v52, v53
    v_cvt_pk_bf16_f32 v39, v54, v55
    v_exp_f32 v56, v56
    v_exp_f32 v57, v57
    v_mfma_f32_32x32x16_bf16 v[72:87], v[20:23], v[36:39], v[72:87]
    ds_read_b128 v[20:23], v88 offset:30112
    v_exp_f32 v58, v58
    v_exp_f32 v59, v59
    v_cvt_pk_bf16_f32 v32, v56, v57
    v_cvt_pk_bf16_f32 v33, v58, v59
    v_exp_f32 v60, v60
    v_exp_f32 v61, v61
    s_waitcnt lgkmcnt(1)
    v_mfma_f32_32x32x16_bf16 v[40:55], v[8:11], v[4:7], 0
    ds_read_b128 v[16:19], v88 offset:29568
    ds_read_b128 v[12:15], v3 offset:31680
    buffer_load_dwordx4 v[188:191], v2, s[8:11], s35 offen offset:3072 sc1
    s_add_u32 s35, s35, 4096
    v_exp_f32 v62, v62
    v_exp_f32 v63, v63
    v_cvt_pk_bf16_f32 v34, v60, v61
    v_cvt_pk_bf16_f32 v35, v62, v63
    v_exp_f32 v64, v64
    v_exp_f32 v65, v65
    v_mfma_f32_32x32x16_bf16 v[72:87], v[24:27], v[32:35], v[72:87]
    v_exp_f32 v66, v66
    v_exp_f32 v67, v67
    v_exp_f32 v68, v68
    v_exp_f32 v69, v69
    v_exp_f32 v70, v70
    v_exp_f32 v71, v71
    v_cvt_pk_bf16_f32 v36, v64, v65
    v_cvt_pk_bf16_f32 v37, v66, v67
    v_cvt_pk_bf16_f32 v38, v68, v69
    v_cvt_pk_bf16_f32 v39, v70, v71
    v_exp_f32 v40, v40
    v_exp_f32 v41, v41
    v_mfma_f32_32x32x16_bf16 v[72:87], v[28:31], v[36:39], v[72:87]
    ds_read_b128 v[28:31], v88 offset:32224
    v_exp_f32 v42, v42
    v_exp_f32 v43, v43
    v_cvt_pk_bf16_f32 v32, v40, v41
    v_cvt_pk_bf16_f32 v33, v42, v43
    v_exp_f32 v44, v44
    v_exp_f32 v45, v45
    s_waitcnt lgkmcnt(1)
    v_mfma_f32_32x32x16_bf16 v[56:71], v[12:15], v[4:7], 0
    ds_read_b128 v[24:27], v88 offset:31680
    ds_read_b128 v[8:11], v3 offset:33792
    buffer_load_dwordx4 v[192:195], v2, s[8:11], s34 offen offset:0 sc1
    v_exp_f32 v46, v46
    v_exp_f32 v47, v47
    v_cvt_pk_bf16_f32 v34, v44, v45
    v_cvt_pk_bf16_f32 v35, v46, v47
    v_exp_f32 v48, v48
    v_exp_f32 v49, v49
    v_mfma_f32_32x32x16_bf16 v[72:87], v[16:19], v[32:35], v[72:87]
    v_exp_f32 v50, v50
    v_exp_f32 v51, v51
    v_exp_f32 v52, v52
    v_exp_f32 v53, v53
    v_exp_f32 v54, v54
    v_exp_f32 v55, v55
    v_cvt_pk_bf16_f32 v36, v48, v49
    v_cvt_pk_bf16_f32 v37, v50, v51
    v_cvt_pk_bf16_f32 v38, v52, v53
    v_cvt_pk_bf16_f32 v39, v54, v55
    v_exp_f32 v56, v56
    v_exp_f32 v57, v57
    v_mfma_f32_32x32x16_bf16 v[72:87], v[20:23], v[36:39], v[72:87]
    ds_read_b128 v[20:23], v88 offset:34336
    v_exp_f32 v58, v58
    v_exp_f32 v59, v59
    v_cvt_pk_bf16_f32 v32, v56, v57
    v_cvt_pk_bf16_f32 v33, v58, v59
    v_exp_f32 v60, v60
    v_exp_f32 v61, v61
    s_waitcnt lgkmcnt(1)
    v_mfma_f32_32x32x16_bf16 v[40:55], v[8:11], v[4:7], 0
    ds_read_b128 v[16:19], v88 offset:33792
    ds_read_b128 v[12:15], v3 offset:35904
    buffer_load_dwordx4 v[196:199], v2, s[8:11], s35 offen offset:0 sc1
    v_exp_f32 v62, v62
    v_exp_f32 v63, v63
    v_cvt_pk_bf16_f32 v34, v60, v61
    v_cvt_pk_bf16_f32 v35, v62, v63
    v_exp_f32 v64, v64
    v_exp_f32 v65, v65
    v_mfma_f32_32x32x16_bf16 v[72:87], v[24:27], v[32:35], v[72:87]
    v_exp_f32 v66, v66
    v_exp_f32 v67, v67
    v_exp_f32 v68, v68
    v_exp_f32 v69, v69
    v_exp_f32 v70, v70
    v_exp_f32 v71, v71
    v_cvt_pk_bf16_f32 v36, v64, v65
    v_cvt_pk_bf16_f32 v37, v66, v67
    v_cvt_pk_bf16_f32 v38, v68, v69
    v_cvt_pk_bf16_f32 v39, v70, v71
    v_add_u32 v3, 33792, v3
    v_add_u32 v88, 33792, v88
    v_exp_f32 v40, v40
    v_exp_f32 v41, v41
    v_mfma_f32_32x32x16_bf16 v[72:87], v[28:31], v[36:39], v[72:87]
    ds_read_b128 v[28:31], v88 offset:2656
    v_exp_f32 v42, v42
    v_exp_f32 v43, v43
    v_cvt_pk_bf16_f32 v32, v40, v41
    v_cvt_pk_bf16_f32 v33, v42, v43
    v_exp_f32 v44, v44
    v_exp_f32 v45, v45
    s_waitcnt lgkmcnt(1)
    v_mfma_f32_32x32x16_bf16 v[56:71], v[12:15], v[4:7], 0
    ds_read_b128 v[24:27], v88 offset:2112
    ds_read_b128 v[8:11], v3 offset:4224
    buffer_load_dwordx4 v[200:203], v2, s[8:11], s34 offen offset:1024 sc1
    v_exp_f32 v46, v46
    v_exp_f32 v47, v47
    v_cvt_pk_bf16_f32 v34, v44, v45
    v_cvt_pk_bf16_f32 v35, v46, v47
    v_exp_f32 v48, v48
    v_exp_f32 v49, v49
    v_mfma_f32_32x32x16_bf16 v[72:87], v[16:19], v[32:35], v[72:87]
    v_exp_f32 v50, v50
    v_exp_f32 v51, v51
    v_exp_f32 v52, v52
    v_exp_f32 v53, v53
    v_exp_f32 v54, v54
    v_exp_f32 v55, v55
    v_cvt_pk_bf16_f32 v36, v48, v49
    v_cvt_pk_bf16_f32 v37, v50, v51
    v_cvt_pk_bf16_f32 v38, v52, v53
    v_cvt_pk_bf16_f32 v39, v54, v55
    v_exp_f32 v56, v56
    v_exp_f32 v57, v57
    v_mfma_f32_32x32x16_bf16 v[72:87], v[20:23], v[36:39], v[72:87]
    ds_read_b128 v[20:23], v88 offset:4768
    v_exp_f32 v58, v58
    v_exp_f32 v59, v59
    v_cvt_pk_bf16_f32 v32, v56, v57
    v_cvt_pk_bf16_f32 v33, v58, v59
    v_exp_f32 v60, v60
    v_exp_f32 v61, v61
    s_waitcnt lgkmcnt(1)
    v_mfma_f32_32x32x16_bf16 v[40:55], v[8:11], v[4:7], 0
    ds_read_b128 v[16:19], v88 offset:4224
    ds_read_b128 v[12:15], v3 offset:6336
    buffer_load_dwordx4 v[204:207], v2, s[8:11], s35 offen offset:1024 sc1
    v_exp_f32 v62, v62
    v_exp_f32 v63, v63
    v_cvt_pk_bf16_f32 v34, v60, v61
    v_cvt_pk_bf16_f32 v35, v62, v63
    v_exp_f32 v64, v64
    v_exp_f32 v65, v65
    v_mfma_f32_32x32x16_bf16 v[72:87], v[24:27], v[32:35], v[72:87]
    v_exp_f32 v66, v66
    v_exp_f32 v67, v67
    v_exp_f32 v68, v68
    v_exp_f32 v69, v69
    v_exp_f32 v70, v70
    v_exp_f32 v71, v71
    v_cvt_pk_bf16_f32 v36, v64, v65
    v_cvt_pk_bf16_f32 v37, v66, v67
    v_cvt_pk_bf16_f32 v38, v68, v69
    v_cvt_pk_bf16_f32 v39, v70, v71
    v_exp_f32 v40, v40
    v_exp_f32 v41, v41
    v_mfma_f32_32x32x16_bf16 v[72:87], v[28:31], v[36:39], v[72:87]
    ds_read_b128 v[28:31], v88 offset:6880
    v_exp_f32 v42, v42
    v_exp_f32 v43, v43
    v_cvt_pk_bf16_f32 v32, v40, v41
    v_cvt_pk_bf16_f32 v33, v42, v43
    v_exp_f32 v44, v44
    v_exp_f32 v45, v45
    s_waitcnt lgkmcnt(1)
    v_mfma_f32_32x32x16_bf16 v[56:71], v[12:15], v[4:7], 0
    ds_read_b128 v[24:27], v88 offset:6336
    ds_read_b128 v[8:11], v3 offset:8448
    buffer_load_dwordx4 v[208:211], v2, s[8:11], s34 offen offset:2048 sc1
    v_exp_f32 v46, v46
    v_exp_f32 v47, v47
    v_cvt_pk_bf16_f32 v34, v44, v45
    v_cvt_pk_bf16_f32 v35, v46, v47
    v_exp_f32 v48, v48
    v_exp_f32 v49, v49
    v_mfma_f32_32x32x16_bf16 v[72:87], v[16:19], v[32:35], v[72:87]
    v_exp_f32 v50, v50
    v_exp_f32 v51, v51
    v_exp_f32 v52, v52
    v_exp_f32 v53, v53
    v_exp_f32 v54, v54
    v_exp_f32 v55, v55
    v_cvt_pk_bf16_f32 v36, v48, v49
    v_cvt_pk_bf16_f32 v37, v50, v51
    v_cvt_pk_bf16_f32 v38, v52, v53
    v_cvt_pk_bf16_f32 v39, v54, v55
    v_exp_f32 v56, v56
    v_exp_f32 v57, v57
    v_mfma_f32_32x32x16_bf16 v[72:87], v[20:23], v[36:39], v[72:87]
    ds_read_b128 v[20:23], v88 offset:8992
    v_exp_f32 v58, v58
    v_exp_f32 v59, v59
    v_cvt_pk_bf16_f32 v32, v56, v57
    v_cvt_pk_bf16_f32 v33, v58, v59
    v_exp_f32 v60, v60
    v_exp_f32 v61, v61
    s_waitcnt lgkmcnt(1)
    v_mfma_f32_32x32x16_bf16 v[40:55], v[8:11], v[4:7], 0
    ds_read_b128 v[16:19], v88 offset:8448
    ds_read_b128 v[12:15], v3 offset:10560
    buffer_load_dwordx4 v[212:215], v2, s[8:11], s35 offen offset:2048 sc1
    v_exp_f32 v62, v62
    v_exp_f32 v63, v63
    v_cvt_pk_bf16_f32 v34, v60, v61
    v_cvt_pk_bf16_f32 v35, v62, v63
    v_exp_f32 v64, v64
    v_exp_f32 v65, v65
    v_mfma_f32_32x32x16_bf16 v[72:87], v[24:27], v[32:35], v[72:87]
    v_exp_f32 v66, v66
    v_exp_f32 v67, v67
    v_exp_f32 v68, v68
    v_exp_f32 v69, v69
    v_exp_f32 v70, v70
    v_exp_f32 v71, v71
    v_cvt_pk_bf16_f32 v36, v64, v65
    v_cvt_pk_bf16_f32 v37, v66, v67
    v_cvt_pk_bf16_f32 v38, v68, v69
    v_cvt_pk_bf16_f32 v39, v70, v71
    v_exp_f32 v40, v40
    v_exp_f32 v41, v41
    v_mfma_f32_32x32x16_bf16 v[72:87], v[28:31], v[36:39], v[72:87]
    ds_read_b128 v[28:31], v88 offset:11104
    v_exp_f32 v42, v42
    v_exp_f32 v43, v43
    v_cvt_pk_bf16_f32 v32, v40, v41
    v_cvt_pk_bf16_f32 v33, v42, v43
    v_exp_f32 v44, v44
    v_exp_f32 v45, v45
    s_waitcnt lgkmcnt(1)
    v_mfma_f32_32x32x16_bf16 v[56:71], v[12:15], v[4:7], 0
    ds_read_b128 v[24:27], v88 offset:10560
    ds_read_b128 v[8:11], v3 offset:12672
    buffer_load_dwordx4 v[216:219], v2, s[8:11], s34 offen offset:3072 sc1
    s_add_u32 s34, s34, 4096
    v_exp_f32 v46, v46
    v_exp_f32 v47, v47
    v_cvt_pk_bf16_f32 v34, v44, v45
    v_cvt_pk_bf16_f32 v35, v46, v47
    v_exp_f32 v48, v48
    v_exp_f32 v49, v49
    v_mfma_f32_32x32x16_bf16 v[72:87], v[16:19], v[32:35], v[72:87]
    v_exp_f32 v50, v50
    v_exp_f32 v51, v51
    v_exp_f32 v52, v52
    v_exp_f32 v53, v53
    v_exp_f32 v54, v54
    v_exp_f32 v55, v55
    v_cvt_pk_bf16_f32 v36, v48, v49
    v_cvt_pk_bf16_f32 v37, v50, v51
    v_cvt_pk_bf16_f32 v38, v52, v53
    v_cvt_pk_bf16_f32 v39, v54, v55
    v_exp_f32 v56, v56
    v_exp_f32 v57, v57
    v_mfma_f32_32x32x16_bf16 v[72:87], v[20:23], v[36:39], v[72:87]
    ds_read_b128 v[20:23], v88 offset:13216
    v_exp_f32 v58, v58
    v_exp_f32 v59, v59
    v_cvt_pk_bf16_f32 v32, v56, v57
    v_cvt_pk_bf16_f32 v33, v58, v59
    v_exp_f32 v60, v60
    v_exp_f32 v61, v61
    s_waitcnt lgkmcnt(1)
    v_mfma_f32_32x32x16_bf16 v[40:55], v[8:11], v[4:7], 0
    ds_read_b128 v[16:19], v88 offset:12672
    ds_read_b128 v[12:15], v3 offset:14784
    buffer_load_dwordx4 v[220:223], v2, s[8:11], s35 offen offset:3072 sc1
    s_add_u32 s35, s35, 4096
    v_exp_f32 v62, v62
    v_exp_f32 v63, v63
    v_cvt_pk_bf16_f32 v34, v60, v61
    v_cvt_pk_bf16_f32 v35, v62, v63
    v_exp_f32 v64, v64
    v_exp_f32 v65, v65
    v_mfma_f32_32x32x16_bf16 v[72:87], v[24:27], v[32:35], v[72:87]
    v_exp_f32 v66, v66
    v_exp_f32 v67, v67
    v_exp_f32 v68, v68
    v_exp_f32 v69, v69
    v_exp_f32 v70, v70
    v_exp_f32 v71, v71
    v_cvt_pk_bf16_f32 v36, v64, v65
    v_cvt_pk_bf16_f32 v37, v66, v67
    v_cvt_pk_bf16_f32 v38, v68, v69
    v_cvt_pk_bf16_f32 v39, v70, v71
    v_exp_f32 v40, v40
    v_exp_f32 v41, v41
    v_mfma_f32_32x32x16_bf16 v[72:87], v[28:31], v[36:39], v[72:87]
    ds_read_b128 v[28:31], v88 offset:15328
    v_exp_f32 v42, v42
    v_exp_f32 v43, v43
    v_cvt_pk_bf16_f32 v32, v40, v41
    v_cvt_pk_bf16_f32 v33, v42, v43
    v_exp_f32 v44, v44
    v_exp_f32 v45, v45
    s_waitcnt lgkmcnt(1)
    v_mfma_f32_32x32x16_bf16 v[56:71], v[12:15], v[4:7], 0
    ds_read_b128 v[24:27], v88 offset:14784
    ds_read_b128 v[8:11], v3 offset:16896
    buffer_load_dwordx4 v[224:227], v2, s[8:11], s30 offen offset:0 sc1
    v_exp_f32 v46, v46
    v_exp_f32 v47, v47
    v_cvt_pk_bf16_f32 v34, v44, v45
    v_cvt_pk_bf16_f32 v35, v46, v47
    v_exp_f32 v48, v48
    v_exp_f32 v49, v49
    v_mfma_f32_32x32x16_bf16 v[72:87], v[16:19], v[32:35], v[72:87]
    v_exp_f32 v50, v50
    v_exp_f32 v51, v51
    v_exp_f32 v52, v52
    v_exp_f32 v53, v53
    v_exp_f32 v54, v54
    v_exp_f32 v55, v55
    v_cvt_pk_bf16_f32 v36, v48, v49
    v_cvt_pk_bf16_f32 v37, v50, v51
    v_cvt_pk_bf16_f32 v38, v52, v53
    v_cvt_pk_bf16_f32 v39, v54, v55
    v_exp_f32 v56, v56
    v_exp_f32 v57, v57
    v_mfma_f32_32x32x16_bf16 v[72:87], v[20:23], v[36:39], v[72:87]
    ds_read_b128 v[20:23], v88 offset:17440
    v_exp_f32 v58, v58
    v_exp_f32 v59, v59
    v_cvt_pk_bf16_f32 v32, v56, v57
    v_cvt_pk_bf16_f32 v33, v58, v59
    v_exp_f32 v60, v60
    v_exp_f32 v61, v61
    s_waitcnt lgkmcnt(1)
    v_mfma_f32_32x32x16_bf16 v[40:55], v[8:11], v[4:7], 0
    ds_read_b128 v[16:19], v88 offset:16896
    ds_read_b128 v[12:15], v3 offset:19008
    buffer_load_dwordx4 v[228:231], v2, s[8:11], s30 offen offset:1024 sc1
    v_exp_f32 v62, v62
    v_exp_f32 v63, v63
    v_cvt_pk_bf16_f32 v34, v60, v61
    v_cvt_pk_bf16_f32 v35, v62, v63
    v_exp_f32 v64, v64
    v_exp_f32 v65, v65
    v_mfma_f32_32x32x16_bf16 v[72:87], v[24:27], v[32:35], v[72:87]
    v_exp_f32 v66, v66
    v_exp_f32 v67, v67
    v_exp_f32 v68, v68
    v_exp_f32 v69, v69
    v_exp_f32 v70, v70
    v_exp_f32 v71, v71
    v_cvt_pk_bf16_f32 v36, v64, v65
    v_cvt_pk_bf16_f32 v37, v66, v67
    v_cvt_pk_bf16_f32 v38, v68, v69
    v_cvt_pk_bf16_f32 v39, v70, v71
    v_exp_f32 v40, v40
    v_exp_f32 v41, v41
    v_mfma_f32_32x32x16_bf16 v[72:87], v[28:31], v[36:39], v[72:87]
    ds_read_b128 v[28:31], v88 offset:19552
    v_exp_f32 v42, v42
    v_exp_f32 v43, v43
    v_cvt_pk_bf16_f32 v32, v40, v41
    v_cvt_pk_bf16_f32 v33, v42, v43
    v_exp_f32 v44, v44
    v_exp_f32 v45, v45
    s_waitcnt lgkmcnt(1)
    v_mfma_f32_32x32x16_bf16 v[56:71], v[12:15], v[4:7], 0
    ds_read_b128 v[24:27], v88 offset:19008
    ds_read_b128 v[8:11], v3 offset:21120
    buffer_load_dwordx4 v[232:235], v2, s[8:11], s30 offen offset:2048 sc1
    v_exp_f32 v46, v46
    v_exp_f32 v47, v47
    v_cvt_pk_bf16_f32 v34, v44, v45
    v_cvt_pk_bf16_f32 v35, v46, v47
    v_exp_f32 v48, v48
    v_exp_f32 v49, v49
    v_mfma_f32_32x32x16_bf16 v[72:87], v[16:19], v[32:35], v[72:87]
    v_exp_f32 v50, v50
    v_exp_f32 v51, v51
    v_exp_f32 v52, v52
    v_exp_f32 v53, v53
    v_exp_f32 v54, v54
    v_exp_f32 v55, v55
    v_cvt_pk_bf16_f32 v36, v48, v49
    v_cvt_pk_bf16_f32 v37, v50, v51
    v_cvt_pk_bf16_f32 v38, v52, v53
    v_cvt_pk_bf16_f32 v39, v54, v55
    v_exp_f32 v56, v56
    v_exp_f32 v57, v57
    v_mfma_f32_32x32x16_bf16 v[72:87], v[20:23], v[36:39], v[72:87]
    ds_read_b128 v[20:23], v88 offset:21664
    v_exp_f32 v58, v58
    v_exp_f32 v59, v59
    v_cvt_pk_bf16_f32 v32, v56, v57
    v_cvt_pk_bf16_f32 v33, v58, v59
    v_exp_f32 v60, v60
    v_exp_f32 v61, v61
    s_waitcnt lgkmcnt(1)
    v_mfma_f32_32x32x16_bf16 v[40:55], v[8:11], v[4:7], 0
    ds_read_b128 v[16:19], v88 offset:21120
    ds_read_b128 v[12:15], v3 offset:23232
    buffer_load_dwordx4 v[236:239], v2, s[8:11], s30 offen offset:3072 sc1
    v_exp_f32 v62, v62
    v_exp_f32 v63, v63
    v_cvt_pk_bf16_f32 v34, v60, v61
    v_cvt_pk_bf16_f32 v35, v62, v63
    v_exp_f32 v64, v64
    v_exp_f32 v65, v65
    v_mfma_f32_32x32x16_bf16 v[72:87], v[24:27], v[32:35], v[72:87]
    v_exp_f32 v66, v66
    v_exp_f32 v67, v67
    v_exp_f32 v68, v68
    v_exp_f32 v69, v69
    v_exp_f32 v70, v70
    v_exp_f32 v71, v71
    v_cvt_pk_bf16_f32 v36, v64, v65
    v_cvt_pk_bf16_f32 v37, v66, v67
    v_cvt_pk_bf16_f32 v38, v68, v69
    v_cvt_pk_bf16_f32 v39, v70, v71
    v_exp_f32 v40, v40
    v_exp_f32 v41, v41
    v_mfma_f32_32x32x16_bf16 v[72:87], v[28:31], v[36:39], v[72:87]
    ds_read_b128 v[28:31], v88 offset:23776
    v_exp_f32 v42, v42
    v_exp_f32 v43, v43
    v_cvt_pk_bf16_f32 v32, v40, v41
    v_cvt_pk_bf16_f32 v33, v42, v43
    v_exp_f32 v44, v44
    v_exp_f32 v45, v45
    s_waitcnt lgkmcnt(1)
    v_mfma_f32_32x32x16_bf16 v[56:71], v[12:15], v[4:7], 0
    ds_read_b128 v[24:27], v88 offset:23232
    ds_read_b128 v[8:11], v3 offset:25344
    s_add_u32 s30, s30, 32768
    buffer_load_dwordx4 v[240:243], v2, s[8:11], s30 offen offset:0 sc1
    v_lshrrev_b32 v92, 3, v1
    v_and_b32 v93, 7, v1
    s_lshl_b32 s25, s17, 6
    s_lshl_b32 s21, s16, 3
    s_add_u32 s25, s25, s21
    v_add_u32 v93, s25, v93
    v_lshlrev_b32 v93, 10, v93
    v_lshl_add_u32 v93, v92, 4, v93
    s_lshl_b32 s21, s18, 7
    v_add_u32 v93, s21, v93
    s_mov_b32 s12, s6
    s_and_b32 s13, s7, 0xffff
    s_mov_b32 s14, 2097152
    s_mov_b32 s15, 0x00020000
    buffer_load_dwordx4 v[92:95], v93, s[12:15], 0 offen
    v_exp_f32 v46, v46
    v_exp_f32 v47, v47
    v_cvt_pk_bf16_f32 v34, v44, v45
    v_cvt_pk_bf16_f32 v35, v46, v47
    v_exp_f32 v48, v48
    v_exp_f32 v49, v49
    v_mfma_f32_32x32x16_bf16 v[72:87], v[16:19], v[32:35], v[72:87]
    v_exp_f32 v50, v50
    v_exp_f32 v51, v51
    v_exp_f32 v52, v52
    v_exp_f32 v53, v53
    v_exp_f32 v54, v54
    v_exp_f32 v55, v55
    v_cvt_pk_bf16_f32 v36, v48, v49
    v_cvt_pk_bf16_f32 v37, v50, v51
    v_cvt_pk_bf16_f32 v38, v52, v53
    v_cvt_pk_bf16_f32 v39, v54, v55
    v_exp_f32 v56, v56
    v_exp_f32 v57, v57
    v_mfma_f32_32x32x16_bf16 v[72:87], v[20:23], v[36:39], v[72:87]
    ds_read_b128 v[20:23], v88 offset:25888
    v_exp_f32 v58, v58
    v_exp_f32 v59, v59
    v_cvt_pk_bf16_f32 v32, v56, v57
    v_cvt_pk_bf16_f32 v33, v58, v59
    v_exp_f32 v60, v60
    v_exp_f32 v61, v61
    s_waitcnt lgkmcnt(1)
    v_mfma_f32_32x32x16_bf16 v[40:55], v[8:11], v[4:7], 0
    ds_read_b128 v[16:19], v88 offset:25344
    ds_read_b128 v[12:15], v3 offset:27456
    buffer_load_dwordx4 v[244:247], v2, s[8:11], s30 offen offset:1024 sc1
    v_exp_f32 v62, v62
    v_exp_f32 v63, v63
    v_cvt_pk_bf16_f32 v34, v60, v61
    v_cvt_pk_bf16_f32 v35, v62, v63
    v_exp_f32 v64, v64
    v_exp_f32 v65, v65
    v_mfma_f32_32x32x16_bf16 v[72:87], v[24:27], v[32:35], v[72:87]
    v_exp_f32 v66, v66
    v_exp_f32 v67, v67
    v_exp_f32 v68, v68
    v_exp_f32 v69, v69
    v_exp_f32 v70, v70
    v_exp_f32 v71, v71
    v_cvt_pk_bf16_f32 v36, v64, v65
    v_cvt_pk_bf16_f32 v37, v66, v67
    v_cvt_pk_bf16_f32 v38, v68, v69
    v_cvt_pk_bf16_f32 v39, v70, v71
    v_exp_f32 v40, v40
    v_exp_f32 v41, v41
    v_mfma_f32_32x32x16_bf16 v[72:87], v[28:31], v[36:39], v[72:87]
    ds_read_b128 v[28:31], v88 offset:28000
    v_exp_f32 v42, v42
    v_exp_f32 v43, v43
    v_cvt_pk_bf16_f32 v32, v40, v41
    v_cvt_pk_bf16_f32 v33, v42, v43
    v_exp_f32 v44, v44
    v_exp_f32 v45, v45
    s_waitcnt lgkmcnt(1)
    v_mfma_f32_32x32x16_bf16 v[56:71], v[12:15], v[4:7], 0
    ds_read_b128 v[24:27], v88 offset:27456
    ds_read_b128 v[8:11], v3 offset:29568
    buffer_load_dwordx4 v[248:251], v2, s[8:11], s30 offen offset:2048 sc1
    s_lshl_b32 s21, s17, 3
    s_add_u32 s21, s21, s16
    s_lshl_b32 s21, s21, 7
    s_add_u32 s38, s21, 25165824
    v_mov_b32 v91, 0
    buffer_load_dword v89, v91, s[8:11], s38 offen sc1
    v_exp_f32 v46, v46
    v_exp_f32 v47, v47
    v_cvt_pk_bf16_f32 v34, v44, v45
    v_cvt_pk_bf16_f32 v35, v46, v47
    v_exp_f32 v48, v48
    v_exp_f32 v49, v49
    v_mfma_f32_32x32x16_bf16 v[72:87], v[16:19], v[32:35], v[72:87]
    v_exp_f32 v50, v50
    v_exp_f32 v51, v51
    v_exp_f32 v52, v52
    v_exp_f32 v53, v53
    v_exp_f32 v54, v54
    v_exp_f32 v55, v55
    v_cvt_pk_bf16_f32 v36, v48, v49
    v_cvt_pk_bf16_f32 v37, v50, v51
    v_cvt_pk_bf16_f32 v38, v52, v53
    v_cvt_pk_bf16_f32 v39, v54, v55
    v_exp_f32 v56, v56
    v_exp_f32 v57, v57
    v_mfma_f32_32x32x16_bf16 v[72:87], v[20:23], v[36:39], v[72:87]
    ds_read_b128 v[20:23], v88 offset:30112
    v_exp_f32 v58, v58
    v_exp_f32 v59, v59
    v_cvt_pk_bf16_f32 v32, v56, v57
    v_cvt_pk_bf16_f32 v33, v58, v59
    v_exp_f32 v60, v60
    v_exp_f32 v61, v61
    s_waitcnt lgkmcnt(1)
    v_mfma_f32_32x32x16_bf16 v[40:55], v[8:11], v[4:7], 0
    ds_read_b128 v[16:19], v88 offset:29568
    ds_read_b128 v[12:15], v3 offset:31680
    buffer_load_dwordx4 v[252:255], v2, s[8:11], s30 offen offset:3072 sc1
    v_exp_f32 v62, v62
    v_exp_f32 v63, v63
    v_cvt_pk_bf16_f32 v34, v60, v61
    v_cvt_pk_bf16_f32 v35, v62, v63
    v_exp_f32 v64, v64
    v_exp_f32 v65, v65
    v_mfma_f32_32x32x16_bf16 v[72:87], v[24:27], v[32:35], v[72:87]
    v_exp_f32 v66, v66
    v_exp_f32 v67, v67
    v_exp_f32 v68, v68
    v_exp_f32 v69, v69
    v_exp_f32 v70, v70
    v_exp_f32 v71, v71
    v_cvt_pk_bf16_f32 v36, v64, v65
    v_cvt_pk_bf16_f32 v37, v66, v67
    v_cvt_pk_bf16_f32 v38, v68, v69
    v_cvt_pk_bf16_f32 v39, v70, v71
    v_exp_f32 v40, v40
    v_exp_f32 v41, v41
    v_mfma_f32_32x32x16_bf16 v[72:87], v[28:31], v[36:39], v[72:87]
    ds_read_b128 v[28:31], v88 offset:32224
    v_exp_f32 v42, v42
    v_exp_f32 v43, v43
    v_cvt_pk_bf16_f32 v32, v40, v41
    v_cvt_pk_bf16_f32 v33, v42, v43
    v_exp_f32 v44, v44
    v_exp_f32 v45, v45
    s_waitcnt lgkmcnt(1)
    v_mfma_f32_32x32x16_bf16 v[56:71], v[12:15], v[4:7], 0
    ds_read_b128 v[24:27], v88 offset:31680
    ds_read_b128 v[8:11], v3 offset:33792
    v_exp_f32 v46, v46
    v_exp_f32 v47, v47
    v_cvt_pk_bf16_f32 v34, v44, v45
    v_cvt_pk_bf16_f32 v35, v46, v47
    v_exp_f32 v48, v48
    v_exp_f32 v49, v49
    v_mfma_f32_32x32x16_bf16 v[72:87], v[16:19], v[32:35], v[72:87]
    v_exp_f32 v50, v50
    v_exp_f32 v51, v51
    v_exp_f32 v52, v52
    v_exp_f32 v53, v53
    v_exp_f32 v54, v54
    v_exp_f32 v55, v55
    v_cvt_pk_bf16_f32 v36, v48, v49
    v_cvt_pk_bf16_f32 v37, v50, v51
    v_cvt_pk_bf16_f32 v38, v52, v53
    v_cvt_pk_bf16_f32 v39, v54, v55
    v_exp_f32 v56, v56
    v_exp_f32 v57, v57
    v_mfma_f32_32x32x16_bf16 v[72:87], v[20:23], v[36:39], v[72:87]
    ds_read_b128 v[20:23], v88 offset:34336
    v_exp_f32 v58, v58
    v_exp_f32 v59, v59
    v_cvt_pk_bf16_f32 v32, v56, v57
    v_cvt_pk_bf16_f32 v33, v58, v59
    v_exp_f32 v60, v60
    v_exp_f32 v61, v61
    s_waitcnt lgkmcnt(1)
    v_mfma_f32_32x32x16_bf16 v[40:55], v[8:11], v[4:7], 0
    ds_read_b128 v[16:19], v88 offset:33792
    ds_read_b128 v[12:15], v3 offset:35904
    v_exp_f32 v62, v62
    v_exp_f32 v63, v63
    v_cvt_pk_bf16_f32 v34, v60, v61
    v_cvt_pk_bf16_f32 v35, v62, v63
    v_exp_f32 v64, v64
    v_exp_f32 v65, v65
    v_mfma_f32_32x32x16_bf16 v[72:87], v[24:27], v[32:35], v[72:87]
    v_exp_f32 v66, v66
    v_exp_f32 v67, v67
    v_exp_f32 v68, v68
    v_exp_f32 v69, v69
    v_exp_f32 v70, v70
    v_exp_f32 v71, v71
    v_cvt_pk_bf16_f32 v36, v64, v65
    v_cvt_pk_bf16_f32 v37, v66, v67
    v_cvt_pk_bf16_f32 v38, v68, v69
    v_cvt_pk_bf16_f32 v39, v70, v71
    s_nop 1
    v_mfma_f32_32x32x16_bf16 v[72:87], v[28:31], v[36:39], v[72:87]
L_join_mk:
    s_mul_i32 s21, s16, 3072
    s_add_u32 s21, s21, 139264
    v_add_u32 v56, s21, v2
    s_xor_b32 s22, s16, 4
    s_mul_i32 s22, s22, 3072
    s_add_u32 s22, s22, 139264
    v_add_u32 v57, s22, v2
    s_nop 7
    s_cmp_ge_u32 s16, 4
    s_cbranch_scc1 L_xw_29
    ds_write_b128 v56, v[72:75] offset:0
    ds_write_b128 v56, v[76:79] offset:1024
    ds_write_b128 v56, v[80:83] offset:2048
L_xw_29:
    s_mov_b32 s22, 0
L_oa_30:
    s_waitcnt vmcnt(0)
    v_cmp_ne_u32 vcc, s62, v89
    s_add_u32 s22, s22, 1
    s_cmp_gt_u32 s22, 200000
    s_cbranch_scc1 L_oad_31
    s_cbranch_vccz L_oad_31
    buffer_load_dword v89, v91, s[8:11], s38 offen sc1
    s_branch L_oa_30
L_oad_31:
    s_lshl_b32 s39, s17, 6
    s_lshl_b32 s22, s16, 2
    s_add_u32 s39, s39, s22
    s_lshl_b32 s39, s39, 10
    s_add_u32 s39, s39, 2097152
    buffer_load_dwordx4 v[16:19], v2, s[8:11], s39 offen offset:0 sc1
    buffer_load_dwordx4 v[20:23], v2, s[8:11], s39 offen offset:1024 sc1
    buffer_load_dwordx4 v[24:27], v2, s[8:11], s39 offen offset:2048 sc1
    buffer_load_dwordx4 v[28:31], v2, s[8:11], s39 offen offset:3072 sc1
    s_waitcnt lgkmcnt(0)
    s_barrier
    s_cmp_lt_u32 s16, 4
    s_cbranch_scc1 L_fb_32
    ds_read_b128 v[44:47], v57 offset:0
    ds_read_b128 v[48:51], v57 offset:1024
    ds_read_b128 v[52:55], v57 offset:2048
    s_waitcnt lgkmcnt(0)
    v_add_f32 v72, v72, v44
    v_add_f32 v73, v73, v45
    v_add_f32 v74, v74, v46
    v_add_f32 v75, v75, v47
    v_add_f32 v76, v76, v48
    v_add_f32 v77, v77, v49
    v_add_f32 v78, v78, v50
    v_add_f32 v79, v79, v51
    v_add_f32 v80, v80, v52
    v_rcp_f32 v80, v80
    s_nop 0
    v_mul_f32 v72, v72, v80
    v_mul_f32 v73, v73, v80
    v_mul_f32 v74, v74, v80
    v_mul_f32 v75, v75, v80
    v_mul_f32 v76, v76, v80
    v_mul_f32 v77, v77, v80
    v_mul_f32 v78, v78, v80
    v_mul_f32 v79, v79, v80
    v_cvt_pk_bf16_f32 v40, v72, v73
    v_cvt_pk_bf16_f32 v41, v74, v75
    v_cvt_pk_bf16_f32 v42, v76, v77
    v_cvt_pk_bf16_f32 v43, v78, v79
    s_add_u32 s21, s20, 32768
    buffer_store_dwordx4 v[40:43], v2, s[8:11], s21 offen sc1
    s_waitcnt vmcnt(1)
    s_branch L_fc_33
L_fb_32:
    s_waitcnt vmcnt(0)
L_fc_33:
    v_mfma_f32_32x32x16_bf16 v[48:63], v[224:227], v[16:19], 0
    v_mfma_f32_32x32x16_bf16 v[48:63], v[228:231], v[20:23], v[48:63]
    v_mfma_f32_32x32x16_bf16 v[48:63], v[232:235], v[24:27], v[48:63]
    v_mfma_f32_32x32x16_bf16 v[48:63], v[236:239], v[28:31], v[48:63]
    v_mfma_f32_32x32x16_bf16 v[64:79], v[240:243], v[16:19], 0
    v_mfma_f32_32x32x16_bf16 v[64:79], v[244:247], v[20:23], v[64:79]
    v_mfma_f32_32x32x16_bf16 v[64:79], v[248:251], v[24:27], v[64:79]
    v_mfma_f32_32x32x16_bf16 v[64:79], v[252:255], v[28:31], v[64:79]
    s_mul_i32 s21, s16, 9216
    s_add_u32 s21, s21, 0
    v_add_u32 v12, s21, v2
    s_nop 7
    s_nop 3
    ds_write_b128 v12, v[48:51] offset:0
    ds_write_b128 v12, v[52:55] offset:1152
    ds_write_b128 v12, v[56:59] offset:2304
    ds_write_b128 v12, v[60:63] offset:3456
    ds_write_b128 v12, v[64:67] offset:4608
    ds_write_b128 v12, v[68:71] offset:5760
    ds_write_b128 v12, v[72:75] offset:6912
    ds_write_b128 v12, v[76:79] offset:8064
    s_waitcnt vmcnt(0) lgkmcnt(0)
    s_barrier
    s_cmp_lg_u32 s16, 0
    s_cbranch_scc1 L_w0_34
    v_mov_b32 v12, s62
    v_mov_b32 v13, 0
    s_lshl_b32 s21, s19, 7
    s_add_u32 s21, s21, 25198592
    s_mov_b64 exec, 1
    s_add_u32 s100, s21, 262144
    buffer_store_dword v12, v13, s[8:11], s100 offen
    buffer_store_dword v12, v13, s[8:11], s21 offen sc1
    s_mov_b64 exec, -1
L_w0_34:
    s_cmp_ge_u32 s16, 4
    s_cbranch_scc1 L_hA_35
    v_lshrrev_b32 v12, 3, v1
    v_mul_u32_u24 v13, 1152, v12
    s_and_b32 s21, s16, 3
    s_lshl_b32 s21, s21, 7
    s_add_u32 s21, s21, 0
    v_and_b32 v14, 7, v1
    v_lshl_add_u32 v13, v14, 4, v13
    v_add_u32 v13, s21, v13
    ds_read_b128 v[32:35], v13 offset:0
    ds_read_b128 v[36:39], v13 offset:512
    ds_read_b128 v[40:43], v13 offset:9216
    ds_read_b128 v[44:47], v13 offset:9728
    ds_read_b128 v[48:51], v13 offset:18432
    ds_read_b128 v[52:55], v13 offset:18944
    ds_read_b128 v[56:59], v13 offset:27648
    ds_read_b128 v[60:63], v13 offset:28160
    ds_read_b128 v[64:67], v13 offset:36864
    ds_read_b128 v[68:71], v13 offset:37376
    ds_read_b128 v[72:75], v13 offset:46080
    ds_read_b128 v[76:79], v13 offset:46592
    ds_read_b128 v[80:83], v13 offset:55296
    ds_read_b128 v[84:87], v13 offset:55808
    ds_read_b128 v[16:19], v13 offset:64512
    ds_read_b128 v[20:23], v13 offset:65024
    s_waitcnt lgkmcnt(12)
    v_add_f32 v32, v32, v40
    v_add_f32 v33, v33, v41
    v_add_f32 v34, v34, v42
    v_add_f32 v35, v35, v43
    v_add_f32 v36, v36, v44
    v_add_f32 v37, v37, v45
    v_add_f32 v38, v38, v46
    v_add_f32 v39, v39, v47
    s_waitcnt lgkmcnt(10)
    v_add_f32 v32, v32, v48
    v_add_f32 v33, v33, v49
    v_add_f32 v34, v34, v50
    v_add_f32 v35, v35, v51
    v_add_f32 v36, v36, v52
    v_add_f32 v37, v37, v53
    v_add_f32 v38, v38, v54
    v_add_f32 v39, v39, v55
    s_waitcnt lgkmcnt(8)
    v_add_f32 v32, v32, v56
    v_add_f32 v33, v33, v57
    v_add_f32 v34, v34, v58
    v_add_f32 v35, v35, v59
    v_add_f32 v36, v36, v60
    v_add_f32 v37, v37, v61
    v_add_f32 v38, v38, v62
    v_add_f32 v39, v39, v63
    s_waitcnt lgkmcnt(6)
    v_add_f32 v32, v32, v64
    v_add_f32 v33, v33, v65
    v_add_f32 v34, v34, v66
    v_add_f32 v35, v35, v67
    v_add_f32 v36, v36, v68
    v_add_f32 v37, v37, v69
    v_add_f32 v38, v38, v70
    v_add_f32 v39, v39, v71
    s_waitcnt lgkmcnt(4)
    v_add_f32 v32, v32, v72
    v_add_f32 v33, v33, v73
    v_add_f32 v34, v34, v74
    v_add_f32 v35, v35, v75
    v_add_f32 v36, v36, v76
    v_add_f32 v37, v37, v77
    v_add_f32 v38, v38, v78
    v_add_f32 v39, v39, v79
    s_waitcnt lgkmcnt(2)
    v_add_f32 v32, v32, v80
    v_add_f32 v33, v33, v81
    v_add_f32 v34, v34, v82
    v_add_f32 v35, v35, v83
    v_add_f32 v36, v36, v84
    v_add_f32 v37, v37, v85
    v_add_f32 v38, v38, v86
    v_add_f32 v39, v39, v87
    s_waitcnt lgkmcnt(0)
    v_add_f32 v32, v32, v16
    v_add_f32 v33, v33, v17
    v_add_f32 v34, v34, v18
    v_add_f32 v35, v35, v19
    v_add_f32 v36, v36, v20
    v_add_f32 v37, v37, v21
    v_add_f32 v38, v38, v22
    v_add_f32 v39, v39, v23
    v_lshlrev_b32 v40, 16, v92
    v_and_b32 v41, 0xffff0000, v92
    v_lshlrev_b32 v42, 16, v93
    v_and_b32 v43, 0xffff0000, v93
    v_lshlrev_b32 v44, 16, v94
    v_and_b32 v45, 0xffff0000, v94
    v_lshlrev_b32 v46, 16, v95
    v_and_b32 v47, 0xffff0000, v95
    v_add_f32 v32, v32, v40
    v_add_f32 v33, v33, v41
    v_add_f32 v34, v34, v42
    v_add_f32 v35, v35, v43
    v_add_f32 v36, v36, v44
    v_add_f32 v37, v37, v45
    v_add_f32 v38, v38, v46
    v_add_f32 v39, v39, v47
    v_cvt_pk_bf16_f32 v92, v32, v33
    v_cvt_pk_bf16_f32 v93, v34, v35
    v_cvt_pk_bf16_f32 v94, v36, v37
    v_cvt_pk_bf16_f32 v95, v38, v39
    v_add_u32 v42, s25, v14
    v_lshrrev_b32 v44, 4, v42
    v_lshlrev_b32 v44, 14, v44
    v_lshrrev_b32 v45, 2, v12
    v_lshl_add_u32 v44, v45, 10, v44
    v_and_b32 v45, 3, v12
    v_lshlrev_b32 v45, 4, v45
    v_and_b32 v46, 15, v42
    v_add_u32 v45, v45, v46
    v_lshl_add_u32 v44, v45, 4, v44
    s_lshl_b32 s21, s18, 11
    s_add_u32 s21, s21, 4194304
    buffer_store_dwordx4 v[92:95], v44, s[8:11], s21 offen sc1
    s_mov_b32 s31, 0x3f803f80
    v_mov_b32 v48, 0
    v_mov_b32 v49, 0
    v_dot2_f32_bf16 v48, v92, s31, v48
    v_dot2_f32_bf16 v49, v92, v92, v49
    v_dot2_f32_bf16 v48, v93, s31, v48
    v_dot2_f32_bf16 v49, v93, v93, v49
    v_dot2_f32_bf16 v48, v94, s31, v48
    v_dot2_f32_bf16 v49, v94, v94, v49
    v_dot2_f32_bf16 v48, v95, s31, v48
    v_dot2_f32_bf16 v49, v95, v95, v49
    s_nop 2
    v_add_f32_dpp v48, v48, v48 row_ror:8 row_mask:0xf bank_mask:0xf
    v_add_f32_dpp v49, v49, v49 row_ror:8 row_mask:0xf bank_mask:0xf
    s_nop 1
    v_mov_b32 v50, v48
    v_mov_b32 v51, v49
    s_nop 1
    v_permlane32_swap_b32 v48, v50
    v_permlane32_swap_b32 v49, v51
    s_nop 1
    v_add_f32 v48, v48, v50
    v_add_f32 v49, v49, v51
    s_nop 0
    v_mov_b32 v50, v48
    v_mov_b32 v51, v49
    s_nop 1
    v_permlane16_swap_b32 v48, v50
    v_permlane16_swap_b32 v49, v51
    s_nop 1
    v_add_f32 v48, v48, v50
    v_add_f32 v49, v49, v51
    v_lshlrev_b32 v45, 3, v42
    s_lshl_b32 s21, s18, 14
    s_add_u32 s21, s21, 6553600
    s_mov_b64 exec, 0xff
    buffer_store_dwordx2 v[48:49], v45, s[8:11], s21 offen sc1
    s_mov_b64 exec, -1
L_hA_35:
    s_lshl_b32 s21, s17, 3
    s_add_u32 s21, s21, s16
    s_lshl_b32 s21, s21, 7
    s_add_u32 s21, s21, 25198592
    v_mov_b32 v13, 0
    v_lshlrev_b32 v13, 7, v1
    s_add_u32 s101, s21, 262144
    s_mov_b32 s22, 0
    s_mov_b32 s100, 0
    s_mov_b32 exec_lo, 0x1
    s_mov_b32 exec_hi, 0
L_polld_36:
    buffer_load_dword v12, v13, s[8:11], s101 offen sc1
    s_waitcnt vmcnt(0)
    v_cmp_eq_u32 vcc, s62, v12
    s_nop 3
    s_or_b32 s100, s100, vcc_lo
    s_cmp_eq_u32 s100, 1
    s_cbranch_scc1 L_pddone_37
    buffer_load_dword v12, v13, s[8:11], s101 offen sc1
    s_waitcnt vmcnt(0)
    v_cmp_eq_u32 vcc, s62, v12
    s_nop 3
    s_or_b32 s100, s100, vcc_lo
    s_cmp_eq_u32 s100, 1
    s_cbranch_scc1 L_pddone_37
    buffer_load_dword v12, v13, s[8:11], s101 offen sc1
    s_waitcnt vmcnt(0)
    v_cmp_eq_u32 vcc, s62, v12
    s_nop 3
    s_or_b32 s100, s100, vcc_lo
    s_cmp_eq_u32 s100, 1
    s_cbranch_scc1 L_pddone_37
    buffer_load_dword v12, v13, s[8:11], s21 offen sc1
    s_add_u32 s22, s22, 1
    s_waitcnt vmcnt(0)
    v_cmp_eq_u32 vcc, s62, v12
    s_nop 3
    s_or_b32 s100, s100, vcc_lo
    s_cmp_eq_u32 s100, 1
    s_cbranch_scc1 L_pddone_37
    s_cmp_gt_u32 s22, 200000
    s_cbranch_scc0 L_polld_36
L_pddone_37:
    s_mov_b64 exec, -1
    s_add_u32 s39, s39, 32768
    buffer_load_dwordx4 v[16:19], v2, s[8:11], s39 offen offset:0 sc1
    buffer_load_dwordx4 v[20:23], v2, s[8:11], s39 offen offset:1024 sc1
    buffer_load_dwordx4 v[24:27], v2, s[8:11], s39 offen offset:2048 sc1
    buffer_load_dwordx4 v[28:31], v2, s[8:11], s39 offen offset:3072 sc1
    s_barrier
    s_cmp_lg_u32 s16, 0
    s_cbranch_scc1 L_w0_39
    v_mov_b32 v12, s62
    v_mov_b32 v13, 0
    s_lshl_b32 s21, s19, 7
    s_add_u32 s21, s21, 25231360
    s_mov_b64 exec, 1
    s_add_u32 s100, s21, 262144
    buffer_store_dword v12, v13, s[8:11], s100 offen
    buffer_store_dword v12, v13, s[8:11], s21 offen sc1
    s_mov_b64 exec, -1
L_w0_39:
    s_lshr_b32 s22, s17, 1
    s_lshl_b32 s21, s22, 1
    s_lshr_b32 s23, s16, 1
    s_and_b32 s23, s23, 1
    s_add_u32 s21, s21, s23
    s_lshl_b32 s36, s21, 10
    s_and_b32 s21, s16, 1
    s_lshl_b32 s23, s23, 2
    s_add_u32 s21, s21, s23
    s_lshl_b32 s23, s22, 3
    s_add_u32 s21, s21, s23
    s_lshl_b32 s21, s21, 14
    s_add_u32 s40, s21, 4194304
    s_and_b32 s41, s16, 3
    s_lshl_b32 s41, s41, 14
    s_waitcnt vmcnt(0)
    v_lshlrev_b32 v13, 7, v1
    v_mfma_f32_32x32x16_bf16 v[48:63], v[224:227], v[16:19], 0
    v_mfma_f32_32x32x16_bf16 v[48:63], v[228:231], v[20:23], v[48:63]
    v_mfma_f32_32x32x16_bf16 v[48:63], v[232:235], v[24:27], v[48:63]
    v_mfma_f32_32x32x16_bf16 v[48:63], v[236:239], v[28:31], v[48:63]
    v_mfma_f32_32x32x16_bf16 v[64:79], v[240:243], v[16:19], 0
    v_mfma_f32_32x32x16_bf16 v[64:79], v[244:247], v[20:23], v[64:79]
    v_mfma_f32_32x32x16_bf16 v[64:79], v[248:251], v[24:27], v[64:79]
    v_mfma_f32_32x32x16_bf16 v[64:79], v[252:255], v[28:31], v[64:79]
    s_mul_i32 s21, s16, 9216
    s_add_u32 s21, s21, 73728
    v_add_u32 v12, s21, v2
    s_nop 7
    s_nop 3
    ds_write_b128 v12, v[48:51] offset:0
    ds_write_b128 v12, v[52:55] offset:1152
    ds_write_b128 v12, v[56:59] offset:2304
    ds_write_b128 v12, v[60:63] offset:3456
    ds_write_b128 v12, v[64:67] offset:4608
    ds_write_b128 v12, v[68:71] offset:5760
    ds_write_b128 v12, v[72:75] offset:6912
    ds_write_b128 v12, v[76:79] offset:8064
    v_lshlrev_b32 v13, 7, v1
    s_add_u32 s21, s36, 25493504
    s_mov_b64 exec, 0xff
    buffer_load_dword v15, v13, s[8:11], s21 offen sc1
    s_mov_b64 exec, -1
    s_waitcnt lgkmcnt(0)
    s_barrier
    s_cmp_lt_u32 s16, 4
    s_cbranch_scc1 L_hB_40
    v_lshrrev_b32 v12, 3, v1
    v_mul_u32_u24 v13, 1152, v12
    s_and_b32 s21, s16, 3
    s_lshl_b32 s21, s21, 7
    s_add_u32 s21, s21, 73728
    v_and_b32 v14, 7, v1
    v_lshl_add_u32 v13, v14, 4, v13
    v_add_u32 v13, s21, v13
    ds_read_b128 v[32:35], v13 offset:0
    ds_read_b128 v[36:39], v13 offset:512
    ds_read_b128 v[40:43], v13 offset:9216
    ds_read_b128 v[44:47], v13 offset:9728
    ds_read_b128 v[48:51], v13 offset:18432
    ds_read_b128 v[52:55], v13 offset:18944
    ds_read_b128 v[56:59], v13 offset:27648
    ds_read_b128 v[60:63], v13 offset:28160
    ds_read_b128 v[64:67], v13 offset:36864
    ds_read_b128 v[68:71], v13 offset:37376
    ds_read_b128 v[72:75], v13 offset:46080
    ds_read_b128 v[76:79], v13 offset:46592
    ds_read_b128 v[80:83], v13 offset:55296
    ds_read_b128 v[84:87], v13 offset:55808
    ds_read_b128 v[16:19], v13 offset:64512
    ds_read_b128 v[20:23], v13 offset:65024
    s_waitcnt lgkmcnt(12)
    v_add_f32 v32, v32, v40
    v_add_f32 v33, v33, v41
    v_add_f32 v34, v34, v42
    v_add_f32 v35, v35, v43
    v_add_f32 v36, v36, v44
    v_add_f32 v37, v37, v45
    v_add_f32 v38, v38, v46
    v_add_f32 v39, v39, v47
    s_waitcnt lgkmcnt(10)
    v_add_f32 v32, v32, v48
    v_add_f32 v33, v33, v49
    v_add_f32 v34, v34, v50
    v_add_f32 v35, v35, v51
    v_add_f32 v36, v36, v52
    v_add_f32 v37, v37, v53
    v_add_f32 v38, v38, v54
    v_add_f32 v39, v39, v55
    s_waitcnt lgkmcnt(8)
    v_add_f32 v32, v32, v56
    v_add_f32 v33, v33, v57
    v_add_f32 v34, v34, v58
    v_add_f32 v35, v35, v59
    v_add_f32 v36, v36, v60
    v_add_f32 v37, v37, v61
    v_add_f32 v38, v38, v62
    v_add_f32 v39, v39, v63
    s_waitcnt lgkmcnt(6)
    v_add_f32 v32, v32, v64
    v_add_f32 v33, v33, v65
    v_add_f32 v34, v34, v66
    v_add_f32 v35, v35, v67
    v_add_f32 v36, v36, v68
    v_add_f32 v37, v37, v69
    v_add_f32 v38, v38, v70
    v_add_f32 v39, v39, v71
    s_waitcnt lgkmcnt(4)
    v_add_f32 v32, v32, v72
    v_add_f32 v33, v33, v73
    v_add_f32 v34, v34, v74
    v_add_f32 v35, v35, v75
    v_add_f32 v36, v36, v76
    v_add_f32 v37, v37, v77
    v_add_f32 v38, v38, v78
    v_add_f32 v39, v39, v79
    s_waitcnt lgkmcnt(2)
    v_add_f32 v32, v32, v80
    v_add_f32 v33, v33, v81
    v_add_f32 v34, v34, v82
    v_add_f32 v35, v35, v83
    v_add_f32 v36, v36, v84
    v_add_f32 v37, v37, v85
    v_add_f32 v38, v38, v86
    v_add_f32 v39, v39, v87
    s_waitcnt lgkmcnt(0)
    v_add_f32 v32, v32, v16
    v_add_f32 v33, v33, v17
    v_add_f32 v34, v34, v18
    v_add_f32 v35, v35, v19
    v_add_f32 v36, v36, v20
    v_add_f32 v37, v37, v21
    v_add_f32 v38, v38, v22
    v_add_f32 v39, v39, v23
    v_lshlrev_b32 v40, 16, v92
    v_and_b32 v41, 0xffff0000, v92
    v_lshlrev_b32 v42, 16, v93
    v_and_b32 v43, 0xffff0000, v93
    v_lshlrev_b32 v44, 16, v94
    v_and_b32 v45, 0xffff0000, v94
    v_lshlrev_b32 v46, 16, v95
    v_and_b32 v47, 0xffff0000, v95
    v_add_f32 v32, v32, v40
    v_add_f32 v33, v33, v41
    v_add_f32 v34, v34, v42
    v_add_f32 v35, v35, v43
    v_add_f32 v36, v36, v44
    v_add_f32 v37, v37, v45
    v_add_f32 v38, v38, v46
    v_add_f32 v39, v39, v47
    v_cvt_pk_bf16_f32 v92, v32, v33
    v_cvt_pk_bf16_f32 v93, v34, v35
    v_cvt_pk_bf16_f32 v94, v36, v37
    v_cvt_pk_bf16_f32 v95, v38, v39
    v_add_u32 v42, s25, v14
    v_lshrrev_b32 v44, 4, v42
    v_lshlrev_b32 v44, 14, v44
    v_lshrrev_b32 v45, 2, v12
    v_lshl_add_u32 v44, v45, 10, v44
    v_and_b32 v45, 3, v12
    v_lshlrev_b32 v45, 4, v45
    v_and_b32 v46, 15, v42
    v_add_u32 v45, v45, v46
    v_lshl_add_u32 v44, v45, 4, v44
    s_lshl_b32 s21, s18, 11
    s_add_u32 s21, s21, 4194304
    buffer_store_dwordx4 v[92:95], v44, s[8:11], s21 offen sc1
    s_mov_b32 s31, 0x3f803f80
    v_mov_b32 v48, 0
    v_mov_b32 v49, 0
    v_dot2_f32_bf16 v48, v92, s31, v48
    v_dot2_f32_bf16 v49, v92, v92, v49
    v_dot2_f32_bf16 v48, v93, s31, v48
    v_dot2_f32_bf16 v49, v93, v93, v49
    v_dot2_f32_bf16 v48, v94, s31, v48
    v_dot2_f32_bf16 v49, v94, v94, v49
    v_dot2_f32_bf16 v48, v95, s31, v48
    v_dot2_f32_bf16 v49, v95, v95, v49
    s_nop 2
    v_add_f32_dpp v48, v48, v48 row_ror:8 row_mask:0xf bank_mask:0xf
    v_add_f32_dpp v49, v49, v49 row_ror:8 row_mask:0xf bank_mask:0xf
    s_nop 1
    v_mov_b32 v50, v48
    v_mov_b32 v51, v49
    s_nop 1
    v_permlane32_swap_b32 v48, v50
    v_permlane32_swap_b32 v49, v51
    s_nop 1
    v_add_f32 v48, v48, v50
    v_add_f32 v49, v49, v51
    s_nop 0
    v_mov_b32 v50, v48
    v_mov_b32 v51, v49
    s_nop 1
    v_permlane16_swap_b32 v48, v50
    v_permlane16_swap_b32 v49, v51
    s_nop 1
    v_add_f32 v48, v48, v50
    v_add_f32 v49, v49, v51
    v_lshlrev_b32 v45, 3, v42
    s_lshl_b32 s21, s18, 14
    s_add_u32 s21, s21, 6553600
    s_mov_b64 exec, 0xff
    buffer_store_dwordx2 v[48:49], v45, s[8:11], s21 offen sc1
    s_mov_b64 exec, -1
    v_lshlrev_b32 v13, 7, v1
    s_mov_b32 s23, 0
    s_waitcnt vmcnt(2)
L_fc_42:
    s_mov_b64 exec, 0xff
    v_cmp_ne_u32 vcc, s62, v15
    s_mov_b64 exec, -1
    s_add_u32 s23, s23, 1
    s_cmp_gt_u32 s23, 200000
    s_cbranch_scc1 L_fcd_43
    s_cbranch_vccz L_fcd_43
    s_add_u32 s21, s36, 25231360
    v_lshlrev_b32 v13, 7, v1
    s_add_u32 s101, s21, 262144
    s_mov_b32 s23, 0
    s_mov_b32 s100, 0
    s_mov_b32 exec_lo, 0xff
    s_mov_b32 exec_hi, 0
L_polld_44:
    buffer_load_dword v15, v13, s[8:11], s101 offen sc1
    s_waitcnt vmcnt(0)
    v_cmp_eq_u32 vcc, s62, v15
    s_nop 3
    s_or_b32 s100, s100, vcc_lo
    s_cmp_eq_u32 s100, 255
    s_cbranch_scc1 L_pddone_45
    buffer_load_dword v15, v13, s[8:11], s101 offen sc1
    s_waitcnt vmcnt(0)
    v_cmp_eq_u32 vcc, s62, v15
    s_nop 3
    s_or_b32 s100, s100, vcc_lo
    s_cmp_eq_u32 s100, 255
    s_cbranch_scc1 L_pddone_45
    buffer_load_dword v15, v13, s[8:11], s101 offen sc1
    s_waitcnt vmcnt(0)
    v_cmp_eq_u32 vcc, s62, v15
    s_nop 3
    s_or_b32 s100, s100, vcc_lo
    s_cmp_eq_u32 s100, 255
    s_cbranch_scc1 L_pddone_45
    buffer_load_dword v15, v13, s[8:11], s21 offen sc1
    s_add_u32 s23, s23, 1
    s_waitcnt vmcnt(0)
    v_cmp_eq_u32 vcc, s62, v15
    s_nop 3
    s_or_b32 s100, s100, vcc_lo
    s_cmp_eq_u32 s100, 255
    s_cbranch_scc1 L_pddone_45
    s_cmp_gt_u32 s23, 200000
    s_cbranch_scc0 L_polld_44
L_pddone_45:
    s_mov_b64 exec, -1
L_fcd_43:
    s_branch L_hBd_41
L_hB_40:
    s_mov_b32 s23, 0
    s_waitcnt vmcnt(0)
L_fc_47:
    s_mov_b64 exec, 0xff
    v_cmp_ne_u32 vcc, s62, v15
    s_mov_b64 exec, -1
    s_add_u32 s23, s23, 1
    s_cmp_gt_u32 s23, 200000
    s_cbranch_scc1 L_fcd_48
    s_cbranch_vccz L_fcd_48
    s_add_u32 s21, s36, 25231360
    v_lshlrev_b32 v13, 7, v1
    s_add_u32 s101, s21, 262144
    s_mov_b32 s23, 0
    s_mov_b32 s100, 0
    s_mov_b32 exec_lo, 0xff
    s_mov_b32 exec_hi, 0
L_polld_49:
    buffer_load_dword v15, v13, s[8:11], s101 offen sc1
    s_waitcnt vmcnt(0)
    v_cmp_eq_u32 vcc, s62, v15
    s_nop 3
    s_or_b32 s100, s100, vcc_lo
    s_cmp_eq_u32 s100, 255
    s_cbranch_scc1 L_pddone_50
    buffer_load_dword v15, v13, s[8:11], s101 offen sc1
    s_waitcnt vmcnt(0)
    v_cmp_eq_u32 vcc, s62, v15
    s_nop 3
    s_or_b32 s100, s100, vcc_lo
    s_cmp_eq_u32 s100, 255
    s_cbranch_scc1 L_pddone_50
    buffer_load_dword v15, v13, s[8:11], s101 offen sc1
    s_waitcnt vmcnt(0)
    v_cmp_eq_u32 vcc, s62, v15
    s_nop 3
    s_or_b32 s100, s100, vcc_lo
    s_cmp_eq_u32 s100, 255
    s_cbranch_scc1 L_pddone_50
    buffer_load_dword v15, v13, s[8:11], s21 offen sc1
    s_add_u32 s23, s23, 1
    s_waitcnt vmcnt(0)
    v_cmp_eq_u32 vcc, s62, v15
    s_nop 3
    s_or_b32 s100, s100, vcc_lo
    s_cmp_eq_u32 s100, 255
    s_cbranch_scc1 L_pddone_50
    s_cmp_gt_u32 s23, 200000
    s_cbranch_scc0 L_polld_49
L_pddone_50:
    s_mov_b64 exec, -1
L_fcd_48:
    s_mov_b32 m0, s41
    s_nop 0
    buffer_load_dwordx4 v2, s[8:11], s40 offen offset:0 sc1 lds
    buffer_load_dwordx4 v2, s[8:11], s40 offen offset:1024 sc1 lds
    buffer_load_dwordx4 v2, s[8:11], s40 offen offset:2048 sc1 lds
    buffer_load_dwordx4 v2, s[8:11], s40 offen offset:3072 sc1 lds
    s_add_u32 s23, s41, 4096
    s_mov_b32 m0, s23
    s_add_u32 s23, s40, 4096
    buffer_load_dwordx4 v2, s[8:11], s23 offen offset:0 sc1 lds
    buffer_load_dwordx4 v2, s[8:11], s23 offen offset:1024 sc1 lds
L_hBd_41:
    v_and_b32 v6, 15, v1
    v_lshrrev_b32 v7, 4, v1
    v_add_u32 v3, 65536, v2
    s_lshr_b32 s23, s16, 2
    s_add_u32 s23, s23, 6
    s_lshl_b32 s23, s23, 10
    s_add_u32 s37, s40, s23
    s_add_u32 s24, s41, s23
    s_cmp_eq_u32 s16, 7
    s_cbranch_scc1 L_w7_mk
    s_and_b32 s26, s19, 15
    s_mul_i32 s26, s26, 7
    s_add_u32 s26, s26, s16
    v_lshlrev_b32 v8, 6, v6
    v_lshl_add_u32 v8, v7, 4, v8
    s_lshl_b32 s21, s26, 10
    s_add_u32 s27, s21, 6946816
    s_add_u32 s21, s21, 6815744
    buffer_load_dwordx4 v[244:247], v8, s[8:11], s21 offen sc1
    buffer_load_dwordx4 v[248:251], v8, s[8:11], s27 offen sc1
    v_lshrrev_b32 v10, 1, v7
    v_lshlrev_b32 v10, 5, v10
    v_add_u32 v10, v10, v6
    v_lshlrev_b32 v10, 4, v10
    v_and_b32 v11, 1, v7
    v_lshl_add_u32 v10, v11, 3, v10
    v_lshlrev_b32 v9, 3, v6
    v_add_u32 v9, 147456, v9
    s_cmp_ge_u32 s16, 4
    s_cbranch_scc1 L_g0_52
    s_waitcnt vmcnt(2)
L_g0_52:
    s_barrier
    ds_read_b128 v[16:19], v2 offset:0
    ds_read_b128 v[20:23], v2 offset:16384
    ds_read_b128 v[24:27], v2 offset:32768
    ds_read_b128 v[28:31], v2 offset:49152
    ds_read_b128 v[32:35], v2 offset:1024
    ds_read_b128 v[36:39], v2 offset:17408
    ds_read_b128 v[40:43], v2 offset:33792
    ds_read_b128 v[44:47], v2 offset:50176
    s_waitcnt lgkmcnt(4)
    v_mfma_f32_16x16x32_bf16 v[48:51], v[96:99], v[16:19], 0
    v_mfma_f32_16x16x32_bf16 v[64:67], v[100:103], v[16:19], 0
    ds_read_b128 v[16:19], v2 offset:2048
    v_mfma_f32_16x16x32_bf16 v[52:55], v[96:99], v[20:23], 0
    v_mfma_f32_16x16x32_bf16 v[68:71], v[100:103], v[20:23], 0
    ds_read_b128 v[20:23], v2 offset:18432
    s_mov_b32 m0, s24
    s_add_u32 s24, s24, 2048
    buffer_load_dwordx4 v2, s[8:11], s37 offen sc1 lds
    s_add_u32 s37, s37, 2048
    v_mfma_f32_16x16x32_bf16 v[56:59], v[96:99], v[24:27], 0
    v_mfma_f32_16x16x32_bf16 v[72:75], v[100:103], v[24:27], 0
    ds_read_b128 v[24:27], v2 offset:34816
    v_mfma_f32_16x16x32_bf16 v[60:63], v[96:99], v[28:31], 0
    v_mfma_f32_16x16x32_bf16 v[76:79], v[100:103], v[28:31], 0
    ds_read_b128 v[28:31], v2 offset:51200
    s_mov_b32 m0, s24
    s_add_u32 s24, s24, 2048
    buffer_load_dwordx4 v2, s[8:11], s37 offen sc1 lds
    s_add_u32 s37, s37, 2048
    s_waitcnt lgkmcnt(4)
    v_mfma_f32_16x16x32_bf16 v[48:51], v[104:107], v[32:35], v[48:51]
    v_mfma_f32_16x16x32_bf16 v[64:67], v[108:111], v[32:35], v[64:67]
    ds_read_b128 v[32:35], v2 offset:3072
    v_mfma_f32_16x16x32_bf16 v[52:55], v[104:107], v[36:39], v[52:55]
    v_mfma_f32_16x16x32_bf16 v[68:71], v[108:111], v[36:39], v[68:71]
    ds_read_b128 v[36:39], v2 offset:19456
    s_mov_b32 m0, s24
    s_add_u32 s24, s24, 2048
    buffer_load_dwordx4 v2, s[8:11], s37 offen sc1 lds
    s_add_u32 s37, s37, 2048
    v_mfma_f32_16x16x32_bf16 v[56:59], v[104:107], v[40:43], v[56:59]
    v_mfma_f32_16x16x32_bf16 v[72:75], v[108:111], v[40:43], v[72:75]
    ds_read_b128 v[40:43], v2 offset:35840
    v_mfma_f32_16x16x32_bf16 v[60:63], v[104:107], v[44:47], v[60:63]
    v_mfma_f32_16x16x32_bf16 v[76:79], v[108:111], v[44:47], v[76:79]
    ds_read_b128 v[44:47], v2 offset:52224
    s_mov_b32 m0, s24
    s_add_u32 s24, s24, 2048
    buffer_load_dwordx4 v2, s[8:11], s37 offen sc1 lds
    s_add_u32 s37, s37, 2048
    s_waitcnt lgkmcnt(4)
    v_mfma_f32_16x16x32_bf16 v[48:51], v[112:115], v[16:19], v[48:51]
    v_mfma_f32_16x16x32_bf16 v[64:67], v[116:119], v[16:19], v[64:67]
    ds_read_b128 v[16:19], v2 offset:4096
    v_mfma_f32_16x16x32_bf16 v[52:55], v[112:115], v[20:23], v[52:55]
    v_mfma_f32_16x16x32_bf16 v[68:71], v[116:119], v[20:23], v[68:71]
    ds_read_b128 v[20:23], v2 offset:20480
    s_mov_b32 m0, s24
    s_add_u32 s24, s24, 2048
    buffer_load_dwordx4 v2, s[8:11], s37 offen sc1 lds
    s_add_u32 s37, s37, 2048
    v_mfma_f32_16x16x32_bf16 v[56:59], v[112:115], v[24:27], v[56:59]
    v_mfma_f32_16x16x32_bf16 v[72:75], v[116:119], v[24:27], v[72:75]
    ds_read_b128 v[24:27], v2 offset:36864
    v_mfma_f32_16x16x32_bf16 v[60:63], v[112:115], v[28:31], v[60:63]
    v_mfma_f32_16x16x32_bf16 v[76:79], v[116:119], v[28:31], v[76:79]
    ds_read_b128 v[28:31], v2 offset:53248
    s_waitcnt lgkmcnt(4)
    v_mfma_f32_16x16x32_bf16 v[48:51], v[120:123], v[32:35], v[48:51]
    v_mfma_f32_16x16x32_bf16 v[64:67], v[124:127], v[32:35], v[64:67]
    ds_read_b128 v[32:35], v2 offset:5120
    v_mfma_f32_16x16x32_bf16 v[52:55], v[120:123], v[36:39], v[52:55]
    v_mfma_f32_16x16x32_bf16 v[68:71], v[124:127], v[36:39], v[68:71]
    ds_read_b128 v[36:39], v2 offset:21504
    v_mfma_f32_16x16x32_bf16 v[56:59], v[120:123], v[40:43], v[56:59]
    v_mfma_f32_16x16x32_bf16 v[72:75], v[124:127], v[40:43], v[72:75]
    ds_read_b128 v[40:43], v2 offset:37888
    s_add_u32 s21, s29, 9216
    buffer_load_dwordx4 v[80:83], v2, s[8:11], s21 offen sc1
    v_mfma_f32_16x16x32_bf16 v[60:63], v[120:123], v[44:47], v[60:63]
    v_mfma_f32_16x16x32_bf16 v[76:79], v[124:127], v[44:47], v[76:79]
    ds_read_b128 v[44:47], v2 offset:54272
    s_waitcnt vmcnt(4)
    s_barrier
    s_cmp_lg_u32 s16, 0
    s_cbranch_scc1 L_w0_53
    v_mov_b32 v14, s62
    v_mov_b32 v11, 0
    s_lshl_b32 s21, s19, 7
    s_add_u32 s21, s21, 25264128
    s_mov_b64 exec, 1
    buffer_store_dword v14, v11, s[8:11], s21 offen sc1
    s_mov_b64 exec, -1
L_w0_53:
    s_waitcnt lgkmcnt(4)
    v_mfma_f32_16x16x32_bf16 v[48:51], v[128:131], v[16:19], v[48:51]
    v_mfma_f32_16x16x32_bf16 v[64:67], v[132:135], v[16:19], v[64:67]
    ds_read_b128 v[16:19], v2 offset:6144
    v_mfma_f32_16x16x32_bf16 v[52:55], v[128:131], v[20:23], v[52:55]
    v_mfma_f32_16x16x32_bf16 v[68:71], v[132:135], v[20:23], v[68:71]
    ds_read_b128 v[20:23], v2 offset:22528
    v_mfma_f32_16x16x32_bf16 v[56:59], v[128:131], v[24:27], v[56:59]
    v_mfma_f32_16x16x32_bf16 v[72:75], v[132:135], v[24:27], v[72:75]
    ds_read_b128 v[24:27], v2 offset:38912
    s_add_u32 s21, s28, 10240
    buffer_load_dwordx4 v[84:87], v2, s[8:11], s21 offen sc1
    v_mfma_f32_16x16x32_bf16 v[60:63], v[128:131], v[28:31], v[60:63]
    v_mfma_f32_16x16x32_bf16 v[76:79], v[132:135], v[28:31], v[76:79]
    ds_read_b128 v[28:31], v2 offset:55296
    s_waitcnt lgkmcnt(4)
    v_mfma_f32_16x16x32_bf16 v[48:51], v[136:139], v[32:35], v[48:51]
    v_mfma_f32_16x16x32_bf16 v[64:67], v[140:143], v[32:35], v[64:67]
    ds_read_b128 v[32:35], v2 offset:7168
    v_mfma_f32_16x16x32_bf16 v[52:55], v[136:139], v[36:39], v[52:55]
    v_mfma_f32_16x16x32_bf16 v[68:71], v[140:143], v[36:39], v[68:71]
    ds_read_b128 v[36:39], v2 offset:23552
    v_mfma_f32_16x16x32_bf16 v[56:59], v[136:139], v[40:43], v[56:59]
    v_mfma_f32_16x16x32_bf16 v[72:75], v[140:143], v[40:43], v[72:75]
    ds_read_b128 v[40:43], v2 offset:39936
    s_add_u32 s21, s29, 10240
    buffer_load_dwordx4 v[88:91], v2, s[8:11], s21 offen sc1
    v_mfma_f32_16x16x32_bf16 v[60:63], v[136:139], v[44:47], v[60:63]
    v_mfma_f32_16x16x32_bf16 v[76:79], v[140:143], v[44:47], v[76:79]
    ds_read_b128 v[44:47], v2 offset:56320
    s_waitcnt lgkmcnt(4)
    v_mfma_f32_16x16x32_bf16 v[48:51], v[144:147], v[16:19], v[48:51]
    v_mfma_f32_16x16x32_bf16 v[64:67], v[148:151], v[16:19], v[64:67]
    ds_read_b128 v[16:19], v2 offset:8192
    v_mfma_f32_16x16x32_bf16 v[52:55], v[144:147], v[20:23], v[52:55]
    v_mfma_f32_16x16x32_bf16 v[68:71], v[148:151], v[20:23], v[68:71]
    ds_read_b128 v[20:23], v2 offset:24576
    v_mfma_f32_16x16x32_bf16 v[56:59], v[144:147], v[24:27], v[56:59]
    v_mfma_f32_16x16x32_bf16 v[72:75], v[148:151], v[24:27], v[72:75]
    ds_read_b128 v[24:27], v2 offset:40960
    s_add_u32 s21, s28, 11264
    buffer_load_dwordx4 v[224:227], v2, s[8:11], s21 offen sc1
    v_mfma_f32_16x16x32_bf16 v[60:63], v[144:147], v[28:31], v[60:63]
    v_mfma_f32_16x16x32_bf16 v[76:79], v[148:151], v[28:31], v[76:79]
    ds_read_b128 v[28:31], v2 offset:57344
    s_waitcnt lgkmcnt(4)
    v_mfma_f32_16x16x32_bf16 v[48:51], v[152:155], v[32:35], v[48:51]
    v_mfma_f32_16x16x32_bf16 v[64:67], v[156:159], v[32:35], v[64:67]
    ds_read_b128 v[32:35], v2 offset:9216
    v_mfma_f32_16x16x32_bf16 v[52:55], v[152:155], v[36:39], v[52:55]
    v_mfma_f32_16x16x32_bf16 v[68:71], v[156:159], v[36:39], v[68:71]
    ds_read_b128 v[36:39], v2 offset:25600
    v_mfma_f32_16x16x32_bf16 v[56:59], v[152:155], v[40:43], v[56:59]
    v_mfma_f32_16x16x32_bf16 v[72:75], v[156:159], v[40:43], v[72:75]
    ds_read_b128 v[40:43], v2 offset:41984
    s_add_u32 s21, s29, 11264
    buffer_load_dwordx4 v[228:231], v2, s[8:11], s21 offen sc1
    v_mfma_f32_16x16x32_bf16 v[60:63], v[152:155], v[44:47], v[60:63]
    v_mfma_f32_16x16x32_bf16 v[76:79], v[156:159], v[44:47], v[76:79]
    ds_read_b128 v[44:47], v2 offset:58368
    s_waitcnt vmcnt(5)
    s_barrier
    s_waitcnt lgkmcnt(4)
    v_mfma_f32_16x16x32_bf16 v[48:51], v[160:163], v[16:19], v[48:51]
    v_mfma_f32_16x16x32_bf16 v[64:67], v[164:167], v[16:19], v[64:67]
    ds_read_b128 v[16:19], v2 offset:10240
    v_mfma_f32_16x16x32_bf16 v[52:55], v[160:163], v[20:23], v[52:55]
    v_mfma_f32_16x16x32_bf16 v[68:71], v[164:167], v[20:23], v[68:71]
    ds_read_b128 v[20:23], v2 offset:26624
    v_mfma_f32_16x16x32_bf16 v[56:59], v[160:163], v[24:27], v[56:59]
    v_mfma_f32_16x16x32_bf16 v[72:75], v[164:167], v[24:27], v[72:75]
    ds_read_b128 v[24:27], v2 offset:43008
    s_add_u32 s21, s28, 12288
    buffer_load_dwordx4 v[232:235], v2, s[8:11], s21 offen sc1
    v_mfma_f32_16x16x32_bf16 v[60:63], v[160:163], v[28:31], v[60:63]
    v_mfma_f32_16x16x32_bf16 v[76:79], v[164:167], v[28:31], v[76:79]
    ds_read_b128 v[28:31], v2 offset:59392
    v_lshlrev_b32 v13, 7, v1
    s_add_u32 s21, s36, 25264128
    s_mov_b64 exec, 0xff
    buffer_load_dword v12, v13, s[8:11], s21 offen sc1
    s_mov_b64 exec, -1
    s_waitcnt lgkmcnt(4)
    v_mfma_f32_16x16x32_bf16 v[48:51], v[168:171], v[32:35], v[48:51]
    v_mfma_f32_16x16x32_bf16 v[64:67], v[172:175], v[32:35], v[64:67]
    ds_read_b128 v[32:35], v2 offset:11264
    v_mfma_f32_16x16x32_bf16 v[52:55], v[168:171], v[36:39], v[52:55]
    v_mfma_f32_16x16x32_bf16 v[68:71], v[172:175], v[36:39], v[68:71]
    ds_read_b128 v[36:39], v2 offset:27648
    v_mfma_f32_16x16x32_bf16 v[56:59], v[168:171], v[40:43], v[56:59]
    v_mfma_f32_16x16x32_bf16 v[72:75], v[172:175], v[40:43], v[72:75]
    ds_read_b128 v[40:43], v2 offset:44032
    s_add_u32 s21, s29, 12288
    buffer_load_dwordx4 v[236:239], v2, s[8:11], s21 offen sc1
    v_mfma_f32_16x16x32_bf16 v[60:63], v[168:171], v[44:47], v[60:63]
    v_mfma_f32_16x16x32_bf16 v[76:79], v[172:175], v[44:47], v[76:79]
    ds_read_b128 v[44:47], v2 offset:60416
    s_waitcnt lgkmcnt(4)
    v_mfma_f32_16x16x32_bf16 v[48:51], v[176:179], v[16:19], v[48:51]
    v_mfma_f32_16x16x32_bf16 v[64:67], v[180:183], v[16:19], v[64:67]
    ds_read_b128 v[16:19], v2 offset:12288
    s_add_u32 s21, s28, 13312
    buffer_load_dwordx4 v[240:243], v2, s[8:11], s21 offen sc1
    v_mfma_f32_16x16x32_bf16 v[52:55], v[176:179], v[20:23], v[52:55]
    v_mfma_f32_16x16x32_bf16 v[68:71], v[180:183], v[20:23], v[68:71]
    ds_read_b128 v[20:23], v2 offset:28672
    v_mfma_f32_16x16x32_bf16 v[56:59], v[176:179], v[24:27], v[56:59]
    v_mfma_f32_16x16x32_bf16 v[72:75], v[180:183], v[24:27], v[72:75]
    ds_read_b128 v[24:27], v2 offset:45056
    s_add_u32 s21, s29, 13312
    buffer_load_dwordx4 v[252:255], v2, s[8:11], s21 offen sc1
    v_mfma_f32_16x16x32_bf16 v[60:63], v[176:179], v[28:31], v[60:63]
    v_mfma_f32_16x16x32_bf16 v[76:79], v[180:183], v[28:31], v[76:79]
    ds_read_b128 v[28:31], v2 offset:61440
    s_waitcnt lgkmcnt(4)
    v_mfma_f32_16x16x32_bf16 v[48:51], v[184:187], v[32:35], v[48:51]
    v_mfma_f32_16x16x32_bf16 v[64:67], v[188:191], v[32:35], v[64:67]
    ds_read_b128 v[32:35], v2 offset:13312
    v_mfma_f32_16x16x32_bf16 v[52:55], v[184:187], v[36:39], v[52:55]
    v_mfma_f32_16x16x32_bf16 v[68:71], v[188:191], v[36:39], v[68:71]
    ds_read_b128 v[36:39], v2 offset:29696
    v_mfma_f32_16x16x32_bf16 v[56:59], v[184:187], v[40:43], v[56:59]
    v_mfma_f32_16x16x32_bf16 v[72:75], v[188:191], v[40:43], v[72:75]
    ds_read_b128 v[40:43], v2 offset:46080
    v_mfma_f32_16x16x32_bf16 v[60:63], v[184:187], v[44:47], v[60:63]
    v_mfma_f32_16x16x32_bf16 v[76:79], v[188:191], v[44:47], v[76:79]
    ds_read_b128 v[44:47], v2 offset:62464
    s_mov_b32 s23, 0
    s_waitcnt vmcnt(3)
L_fc_54:
    s_mov_b64 exec, 0xff
    v_cmp_ne_u32 vcc, s62, v12
    s_mov_b64 exec, -1
    s_add_u32 s23, s23, 1
    s_cmp_gt_u32 s23, 200000
    s_cbranch_scc1 L_fcd_55
    s_cbranch_vccz L_fcd_55
    v_lshlrev_b32 v13, 7, v1
    s_add_u32 s21, s36, 25264128
    s_mov_b64 exec, 0xff
    buffer_load_dword v12, v13, s[8:11], s21 offen sc1
    s_mov_b64 exec, -1
    s_waitcnt vmcnt(0)
    s_branch L_fc_54
L_fcd_55:
    s_lshr_b32 s23, s16, 2
    s_add_u32 s23, s23, 0
    s_lshl_b32 s23, s23, 10
    s_add_u32 s37, s40, s23
    s_add_u32 s24, s41, s23
    s_add_u32 s37, s37, 32768
    s_add_u32 s24, s24, 65536
    s_waitcnt lgkmcnt(4)
    v_mfma_f32_16x16x32_bf16 v[48:51], v[192:195], v[16:19], v[48:51]
    v_mfma_f32_16x16x32_bf16 v[64:67], v[196:199], v[16:19], v[64:67]
    ds_read_b128 v[16:19], v2 offset:14336
    v_mfma_f32_16x16x32_bf16 v[52:55], v[192:195], v[20:23], v[52:55]
    v_mfma_f32_16x16x32_bf16 v[68:71], v[196:199], v[20:23], v[68:71]
    ds_read_b128 v[20:23], v2 offset:30720
    s_mov_b32 m0, s24
    s_add_u32 s24, s24, 2048
    buffer_load_dwordx4 v2, s[8:11], s37 offen sc1 lds
    s_add_u32 s37, s37, 2048
    v_mfma_f32_16x16x32_bf16 v[56:59], v[192:195], v[24:27], v[56:59]
    v_mfma_f32_16x16x32_bf16 v[72:75], v[196:199], v[24:27], v[72:75]
    ds_read_b128 v[24:27], v2 offset:47104
    v_mfma_f32_16x16x32_bf16 v[60:63], v[192:195], v[28:31], v[60:63]
    v_mfma_f32_16x16x32_bf16 v[76:79], v[196:199], v[28:31], v[76:79]
    ds_read_b128 v[28:31], v2 offset:63488
    s_mov_b32 m0, s24
    s_add_u32 s24, s24, 2048
    buffer_load_dwordx4 v2, s[8:11], s37 offen sc1 lds
    s_add_u32 s37, s37, 2048
    s_waitcnt lgkmcnt(4)
    v_mfma_f32_16x16x32_bf16 v[48:51], v[200:203], v[32:35], v[48:51]
    v_mfma_f32_16x16x32_bf16 v[64:67], v[204:207], v[32:35], v[64:67]
    ds_read_b128 v[32:35], v2 offset:15360
    v_mfma_f32_16x16x32_bf16 v[52:55], v[200:203], v[36:39], v[52:55]
    v_mfma_f32_16x16x32_bf16 v[68:71], v[204:207], v[36:39], v[68:71]
    ds_read_b128 v[36:39], v2 offset:31744
    s_mov_b32 m0, s24
    s_add_u32 s24, s24, 2048
    buffer_load_dwordx4 v2, s[8:11], s37 offen sc1 lds
    s_add_u32 s37, s37, 2048
    v_mfma_f32_16x16x32_bf16 v[56:59], v[200:203], v[40:43], v[56:59]
    v_mfma_f32_16x16x32_bf16 v[72:75], v[204:207], v[40:43], v[72:75]
    ds_read_b128 v[40:43], v2 offset:48128
    v_mfma_f32_16x16x32_bf16 v[60:63], v[200:203], v[44:47], v[60:63]
    v_mfma_f32_16x16x32_bf16 v[76:79], v[204:207], v[44:47], v[76:79]
    ds_read_b128 v[44:47], v2 offset:64512
    s_mov_b32 m0, s24
    s_add_u32 s24, s24, 2048
    buffer_load_dwordx4 v2, s[8:11], s37 offen sc1 lds
    s_add_u32 s37, s37, 2048
    s_waitcnt lgkmcnt(4)
    v_mfma_f32_16x16x32_bf16 v[48:51], v[208:211], v[16:19], v[48:51]
    v_mfma_f32_16x16x32_bf16 v[64:67], v[212:215], v[16:19], v[64:67]
    v_mfma_f32_16x16x32_bf16 v[52:55], v[208:211], v[20:23], v[52:55]
    v_mfma_f32_16x16x32_bf16 v[68:71], v[212:215], v[20:23], v[68:71]
    s_mov_b32 m0, s24
    s_add_u32 s24, s24, 2048
    buffer_load_dwordx4 v2, s[8:11], s37 offen sc1 lds
    s_add_u32 s37, s37, 2048
    v_mfma_f32_16x16x32_bf16 v[56:59], v[208:211], v[24:27], v[56:59]
    v_mfma_f32_16x16x32_bf16 v[72:75], v[212:215], v[24:27], v[72:75]
    v_mfma_f32_16x16x32_bf16 v[60:63], v[208:211], v[28:31], v[60:63]
    v_mfma_f32_16x16x32_bf16 v[76:79], v[212:215], v[28:31], v[76:79]
    s_mov_b32 m0, s24
    s_add_u32 s24, s24, 2048
    buffer_load_dwordx4 v2, s[8:11], s37 offen sc1 lds
    s_add_u32 s37, s37, 2048
    s_waitcnt lgkmcnt(0)
    v_mfma_f32_16x16x32_bf16 v[48:51], v[216:219], v[32:35], v[48:51]
    v_mfma_f32_16x16x32_bf16 v[64:67], v[220:223], v[32:35], v[64:67]
    v_mfma_f32_16x16x32_bf16 v[52:55], v[216:219], v[36:39], v[52:55]
    v_mfma_f32_16x16x32_bf16 v[68:71], v[220:223], v[36:39], v[68:71]
    s_mov_b32 m0, s24
    s_add_u32 s24, s24, 2048
    buffer_load_dwordx4 v2, s[8:11], s37 offen sc1 lds
    s_add_u32 s37, s37, 2048
    v_mfma_f32_16x16x32_bf16 v[56:59], v[216:219], v[40:43], v[56:59]
    v_mfma_f32_16x16x32_bf16 v[72:75], v[220:223], v[40:43], v[72:75]
    v_mfma_f32_16x16x32_bf16 v[60:63], v[216:219], v[44:47], v[60:63]
    v_mfma_f32_16x16x32_bf16 v[76:79], v[220:223], v[44:47], v[76:79]
    s_mov_b32 m0, s24
    s_add_u32 s24, s24, 2048
    buffer_load_dwordx4 v2, s[8:11], s37 offen sc1 lds
    s_add_u32 s37, s37, 2048
    v_add_f32_dpp v244, v244, v244 row_ror:8 row_mask:0xf bank_mask:0xf
    v_add_f32_dpp v245, v245, v245 row_ror:8 row_mask:0xf bank_mask:0xf
    v_add_f32_dpp v246, v246, v246 row_ror:8 row_mask:0xf bank_mask:0xf
    v_add_f32_dpp v247, v247, v247 row_ror:8 row_mask:0xf bank_mask:0xf
    v_add_f32_dpp v248, v248, v248 row_ror:8 row_mask:0xf bank_mask:0xf
    v_add_f32_dpp v249, v249, v249 row_ror:8 row_mask:0xf bank_mask:0xf
    v_add_f32_dpp v250, v250, v250 row_ror:8 row_mask:0xf bank_mask:0xf
    v_add_f32_dpp v251, v251, v251 row_ror:8 row_mask:0xf bank_mask:0xf
    v_add_f32_dpp v244, v244, v244 row_ror:4 row_mask:0xf bank_mask:0xf
    v_add_f32_dpp v245, v245, v245 row_ror:4 row_mask:0xf bank_mask:0xf
    v_add_f32_dpp v246, v246, v246 row_ror:4 row_mask:0xf bank_mask:0xf
    v_add_f32_dpp v247, v247, v247 row_ror:4 row_mask:0xf bank_mask:0xf
    v_add_f32_dpp v248, v248, v248 row_ror:4 row_mask:0xf bank_mask:0xf
    v_add_f32_dpp v249, v249, v249 row_ror:4 row_mask:0xf bank_mask:0xf
    v_add_f32_dpp v250, v250, v250 row_ror:4 row_mask:0xf bank_mask:0xf
    v_add_f32_dpp v251, v251, v251 row_ror:4 row_mask:0xf bank_mask:0xf
    v_add_f32_dpp v244, v244, v244 row_ror:2 row_mask:0xf bank_mask:0xf
    v_add_f32_dpp v245, v245, v245 row_ror:2 row_mask:0xf bank_mask:0xf
    v_add_f32_dpp v246, v246, v246 row_ror:2 row_mask:0xf bank_mask:0xf
    v_add_f32_dpp v247, v247, v247 row_ror:2 row_mask:0xf bank_mask:0xf
    v_add_f32_dpp v248, v248, v248 row_ror:2 row_mask:0xf bank_mask:0xf
    v_add_f32_dpp v249, v249, v249 row_ror:2 row_mask:0xf bank_mask:0xf
    v_add_f32_dpp v250, v250, v250 row_ror:2 row_mask:0xf bank_mask:0xf
    v_add_f32_dpp v251, v251, v251 row_ror:2 row_mask:0xf bank_mask:0xf
    v_add_f32_dpp v244, v244, v244 row_ror:1 row_mask:0xf bank_mask:0xf
    v_add_f32_dpp v245, v245, v245 row_ror:1 row_mask:0xf bank_mask:0xf
    v_add_f32_dpp v246, v246, v246 row_ror:1 row_mask:0xf bank_mask:0xf
    v_add_f32_dpp v247, v247, v247 row_ror:1 row_mask:0xf bank_mask:0xf
    v_add_f32_dpp v248, v248, v248 row_ror:1 row_mask:0xf bank_mask:0xf
    v_add_f32_dpp v249, v249, v249 row_ror:1 row_mask:0xf bank_mask:0xf
    v_add_f32_dpp v250, v250, v250 row_ror:1 row_mask:0xf bank_mask:0xf
    v_add_f32_dpp v251, v251, v251 row_ror:1 row_mask:0xf bank_mask:0xf
    ds_read_b64 v[16:17], v9 offset:0
    ds_read_b64 v[18:19], v9 offset:128
    ds_read_b64 v[20:21], v9 offset:512
    ds_read_b64 v[22:23], v9 offset:640
    s_mul_i32 s21, s22, 448
    s_add_u32 s21, s21, s26
    s_lshl_b32 s21, s21, 10
    s_add_u32 s21, s21, 16777216
    s_waitcnt lgkmcnt(0)
    v_fma_f32 v48, -v16, v244, v48
    v_fma_f32 v64, -v16, v248, v64
    v_fma_f32 v49, -v16, v245, v49
    v_fma_f32 v65, -v16, v249, v65
    v_fma_f32 v50, -v16, v246, v50
    v_fma_f32 v66, -v16, v250, v66
    v_fma_f32 v51, -v16, v247, v51
    v_fma_f32 v67, -v16, v251, v67
    v_max_f32 v48, 0, v48
    v_mul_f32 v64, v64, v17
    v_max_f32 v49, 0, v49
    v_mul_f32 v65, v65, v17
    v_max_f32 v50, 0, v50
    v_mul_f32 v66, v66, v17
    v_max_f32 v51, 0, v51
    v_mul_f32 v67, v67, v17
    v_mul_f32 v48, v48, v64
    v_mul_f32 v49, v49, v65
    v_mul_f32 v50, v50, v66
    v_mul_f32 v51, v51, v67
    v_cvt_pk_bf16_f32 v48, v48, v49
    v_cvt_pk_bf16_f32 v49, v50, v51
    v_fma_f32 v52, -v18, v244, v52
    v_fma_f32 v68, -v18, v248, v68
    v_fma_f32 v53, -v18, v245, v53
    v_fma_f32 v69, -v18, v249, v69
    v_fma_f32 v54, -v18, v246, v54
    v_fma_f32 v70, -v18, v250, v70
    v_fma_f32 v55, -v18, v247, v55
    v_fma_f32 v71, -v18, v251, v71
    v_max_f32 v52, 0, v52
    v_mul_f32 v68, v68, v19
    v_max_f32 v53, 0, v53
    v_mul_f32 v69, v69, v19
    v_max_f32 v54, 0, v54
    v_mul_f32 v70, v70, v19
    v_max_f32 v55, 0, v55
    v_mul_f32 v71, v71, v19
    v_mul_f32 v52, v52, v68
    v_mul_f32 v53, v53, v69
    v_mul_f32 v54, v54, v70
    v_mul_f32 v55, v55, v71
    v_cvt_pk_bf16_f32 v50, v52, v53
    v_cvt_pk_bf16_f32 v51, v54, v55
    s_nop 1
    v_permlane16_swap_b32 v48, v50
    v_permlane16_swap_b32 v49, v51
    buffer_store_dwordx4 v[48:51], v2, s[8:11], s21 offen sc1
    s_add_u32 s21, s21, 229376
    v_fma_f32 v56, -v20, v244, v56
    v_fma_f32 v72, -v20, v248, v72
    v_fma_f32 v57, -v20, v245, v57
    v_fma_f32 v73, -v20, v249, v73
    v_fma_f32 v58, -v20, v246, v58
    v_fma_f32 v74, -v20, v250, v74
    v_fma_f32 v59, -v20, v247, v59
    v_fma_f32 v75, -v20, v251, v75
    v_max_f32 v56, 0, v56
    v_mul_f32 v72, v72, v21
    v_max_f32 v57, 0, v57
    v_mul_f32 v73, v73, v21
    v_max_f32 v58, 0, v58
    v_mul_f32 v74, v74, v21
    v_max_f32 v59, 0, v59
    v_mul_f32 v75, v75, v21
    v_mul_f32 v56, v56, v72
    v_mul_f32 v57, v57, v73
    v_mul_f32 v58, v58, v74
    v_mul_f32 v59, v59, v75
    v_cvt_pk_bf16_f32 v56, v56, v57
    v_cvt_pk_bf16_f32 v57, v58, v59
    v_fma_f32 v60, -v22, v244, v60
    v_fma_f32 v76, -v22, v248, v76
    v_fma_f32 v61, -v22, v245, v61
    v_fma_f32 v77, -v22, v249, v77
    v_fma_f32 v62, -v22, v246, v62
    v_fma_f32 v78, -v22, v250, v78
    v_fma_f32 v63, -v22, v247, v63
    v_fma_f32 v79, -v22, v251, v79
    v_max_f32 v60, 0, v60
    v_mul_f32 v76, v76, v23
    v_max_f32 v61, 0, v61
    v_mul_f32 v77, v77, v23
    v_max_f32 v62, 0, v62
    v_mul_f32 v78, v78, v23
    v_max_f32 v63, 0, v63
    v_mul_f32 v79, v79, v23
    v_mul_f32 v60, v60, v76
    v_mul_f32 v61, v61, v77
    v_mul_f32 v62, v62, v78
    v_mul_f32 v63, v63, v79
    v_cvt_pk_bf16_f32 v58, v60, v61
    v_cvt_pk_bf16_f32 v59, v62, v63
    s_nop 1
    v_permlane16_swap_b32 v56, v58
    v_permlane16_swap_b32 v57, v59
    buffer_store_dwordx4 v[56:59], v2, s[8:11], s21 offen sc1
    s_waitcnt vmcnt(2)
    s_barrier
    ds_read_b128 v[16:19], v3 offset:0
    ds_read_b128 v[20:23], v3 offset:16384
    ds_read_b128 v[24:27], v3 offset:32768
    ds_read_b128 v[28:31], v3 offset:49152
    ds_read_b128 v[32:35], v3 offset:1024
    ds_read_b128 v[36:39], v3 offset:17408
    ds_read_b128 v[40:43], v3 offset:33792
    ds_read_b128 v[44:47], v3 offset:50176
    s_waitcnt lgkmcnt(4)
    v_mfma_f32_16x16x32_bf16 v[48:51], v[96:99], v[16:19], 0
    v_mfma_f32_16x16x32_bf16 v[64:67], v[100:103], v[16:19], 0
    ds_read_b128 v[16:19], v3 offset:2048
    v_mfma_f32_16x16x32_bf16 v[52:55], v[96:99], v[20:23], 0
    v_mfma_f32_16x16x32_bf16 v[68:71], v[100:103], v[20:23], 0
    ds_read_b128 v[20:23], v3 offset:18432
    v_mfma_f32_16x16x32_bf16 v[56:59], v[96:99], v[24:27], 0
    v_mfma_f32_16x16x32_bf16 v[72:75], v[100:103], v[24:27], 0
    ds_read_b128 v[24:27], v3 offset:34816
    v_mfma_f32_16x16x32_bf16 v[60:63], v[96:99], v[28:31], 0
    v_mfma_f32_16x16x32_bf16 v[76:79], v[100:103], v[28:31], 0
    ds_read_b128 v[28:31], v3 offset:51200
    s_waitcnt lgkmcnt(4)
    v_mfma_f32_16x16x32_bf16 v[48:51], v[104:107], v[32:35], v[48:51]
    v_mfma_f32_16x16x32_bf16 v[64:67], v[108:111], v[32:35], v[64:67]
    ds_read_b128 v[32:35], v3 offset:3072
    v_mfma_f32_16x16x32_bf16 v[52:55], v[104:107], v[36:39], v[52:55]
    v_mfma_f32_16x16x32_bf16 v[68:71], v[108:111], v[36:39], v[68:71]
    ds_read_b128 v[36:39], v3 offset:19456
    s_add_u32 s21, s28, 0
    buffer_load_dwordx4 v[96:99], v2, s[8:11], s21 offen sc1
    v_mfma_f32_16x16x32_bf16 v[56:59], v[104:107], v[40:43], v[56:59]
    v_mfma_f32_16x16x32_bf16 v[72:75], v[108:111], v[40:43], v[72:75]
    ds_read_b128 v[40:43], v3 offset:35840
    v_mfma_f32_16x16x32_bf16 v[60:63], v[104:107], v[44:47], v[60:63]
    v_mfma_f32_16x16x32_bf16 v[76:79], v[108:111], v[44:47], v[76:79]
    ds_read_b128 v[44:47], v3 offset:52224
    s_add_u32 s21, s29, 0
    buffer_load_dwordx4 v[100:103], v2, s[8:11], s21 offen sc1
    s_waitcnt lgkmcnt(4)
    v_mfma_f32_16x16x32_bf16 v[48:51], v[112:115], v[16:19], v[48:51]
    v_mfma_f32_16x16x32_bf16 v[64:67], v[116:119], v[16:19], v[64:67]
    ds_read_b128 v[16:19], v3 offset:4096
    v_mfma_f32_16x16x32_bf16 v[52:55], v[112:115], v[20:23], v[52:55]
    v_mfma_f32_16x16x32_bf16 v[68:71], v[116:119], v[20:23], v[68:71]
    ds_read_b128 v[20:23], v3 offset:20480
    s_add_u32 s21, s28, 1024
    buffer_load_dwordx4 v[104:107], v2, s[8:11], s21 offen sc1
    v_mfma_f32_16x16x32_bf16 v[56:59], v[112:115], v[24:27], v[56:59]
    v_mfma_f32_16x16x32_bf16 v[72:75], v[116:119], v[24:27], v[72:75]
    ds_read_b128 v[24:27], v3 offset:36864
    v_mfma_f32_16x16x32_bf16 v[60:63], v[112:115], v[28:31], v[60:63]
    v_mfma_f32_16x16x32_bf16 v[76:79], v[116:119], v[28:31], v[76:79]
    ds_read_b128 v[28:31], v3 offset:53248
    s_add_u32 s21, s29, 1024
    buffer_load_dwordx4 v[108:111], v2, s[8:11], s21 offen sc1
    s_waitcnt lgkmcnt(4)
    v_mfma_f32_16x16x32_bf16 v[48:51], v[120:123], v[32:35], v[48:51]
    v_mfma_f32_16x16x32_bf16 v[64:67], v[124:127], v[32:35], v[64:67]
    ds_read_b128 v[32:35], v3 offset:5120
    v_mfma_f32_16x16x32_bf16 v[52:55], v[120:123], v[36:39], v[52:55]
    v_mfma_f32_16x16x32_bf16 v[68:71], v[124:127], v[36:39], v[68:71]
    ds_read_b128 v[36:39], v3 offset:21504
    s_add_u32 s21, s28, 2048
    buffer_load_dwordx4 v[112:115], v2, s[8:11], s21 offen sc1
    v_mfma_f32_16x16x32_bf16 v[56:59], v[120:123], v[40:43], v[56:59]
    v_mfma_f32_16x16x32_bf16 v[72:75], v[124:127], v[40:43], v[72:75]
    ds_read_b128 v[40:43], v3 offset:37888
    v_mfma_f32_16x16x32_bf16 v[60:63], v[120:123], v[44:47], v[60:63]
    v_mfma_f32_16x16x32_bf16 v[76:79], v[124:127], v[44:47], v[76:79]
    ds_read_b128 v[44:47], v3 offset:54272
    s_add_u32 s21, s29, 2048
    buffer_load_dwordx4 v[116:119], v2, s[8:11], s21 offen sc1
    s_waitcnt lgkmcnt(4)
    v_mfma_f32_16x16x32_bf16 v[48:51], v[128:131], v[16:19], v[48:51]
    v_mfma_f32_16x16x32_bf16 v[64:67], v[132:135], v[16:19], v[64:67]
    ds_read_b128 v[16:19], v3 offset:6144
    v_mfma_f32_16x16x32_bf16 v[52:55], v[128:131], v[20:23], v[52:55]
    v_mfma_f32_16x16x32_bf16 v[68:71], v[132:135], v[20:23], v[68:71]
    ds_read_b128 v[20:23], v3 offset:22528
    s_add_u32 s21, s28, 3072
    buffer_load_dwordx4 v[120:123], v2, s[8:11], s21 offen sc1
    v_mfma_f32_16x16x32_bf16 v[56:59], v[128:131], v[24:27], v[56:59]
    v_mfma_f32_16x16x32_bf16 v[72:75], v[132:135], v[24:27], v[72:75]
    ds_read_b128 v[24:27], v3 offset:38912
    v_mfma_f32_16x16x32_bf16 v[60:63], v[128:131], v[28:31], v[60:63]
    v_mfma_f32_16x16x32_bf16 v[76:79], v[132:135], v[28:31], v[76:79]
    ds_read_b128 v[28:31], v3 offset:55296
    s_add_u32 s21, s29, 3072
    buffer_load_dwordx4 v[124:127], v2, s[8:11], s21 offen sc1
    s_waitcnt lgkmcnt(4)
    v_mfma_f32_16x16x32_bf16 v[48:51], v[136:139], v[32:35], v[48:51]
    v_mfma_f32_16x16x32_bf16 v[64:67], v[140:143], v[32:35], v[64:67]
    ds_read_b128 v[32:35], v3 offset:7168
    v_mfma_f32_16x16x32_bf16 v[52:55], v[136:139], v[36:39], v[52:55]
    v_mfma_f32_16x16x32_bf16 v[68:71], v[140:143], v[36:39], v[68:71]
    ds_read_b128 v[36:39], v3 offset:23552
    s_add_u32 s21, s28, 4096
    buffer_load_dwordx4 v[128:131], v2, s[8:11], s21 offen sc1
    v_mfma_f32_16x16x32_bf16 v[56:59], v[136:139], v[40:43], v[56:59]
    v_mfma_f32_16x16x32_bf16 v[72:75], v[140:143], v[40:43], v[72:75]
    ds_read_b128 v[40:43], v3 offset:39936
    v_mfma_f32_16x16x32_bf16 v[60:63], v[136:139], v[44:47], v[60:63]
    v_mfma_f32_16x16x32_bf16 v[76:79], v[140:143], v[44:47], v[76:79]
    ds_read_b128 v[44:47], v3 offset:56320
    s_add_u32 s21, s29, 4096
    buffer_load_dwordx4 v[132:135], v2, s[8:11], s21 offen sc1
    s_waitcnt lgkmcnt(4)
    v_mfma_f32_16x16x32_bf16 v[48:51], v[144:147], v[16:19], v[48:51]
    v_mfma_f32_16x16x32_bf16 v[64:67], v[148:151], v[16:19], v[64:67]
    ds_read_b128 v[16:19], v3 offset:8192
    v_mfma_f32_16x16x32_bf16 v[52:55], v[144:147], v[20:23], v[52:55]
    v_mfma_f32_16x16x32_bf16 v[68:71], v[148:151], v[20:23], v[68:71]
    ds_read_b128 v[20:23], v3 offset:24576
    s_add_u32 s21, s28, 5120
    buffer_load_dwordx4 v[136:139], v2, s[8:11], s21 offen sc1
    v_mfma_f32_16x16x32_bf16 v[56:59], v[144:147], v[24:27], v[56:59]
    v_mfma_f32_16x16x32_bf16 v[72:75], v[148:151], v[24:27], v[72:75]
    ds_read_b128 v[24:27], v3 offset:40960
    v_mfma_f32_16x16x32_bf16 v[60:63], v[144:147], v[28:31], v[60:63]
    v_mfma_f32_16x16x32_bf16 v[76:79], v[148:151], v[28:31], v[76:79]
    ds_read_b128 v[28:31], v3 offset:57344
    s_add_u32 s21, s29, 5120
    buffer_load_dwordx4 v[140:143], v2, s[8:11], s21 offen sc1
    s_waitcnt vmcnt(12)
    s_barrier
    s_cmp_lg_u32 s16, 0
    s_cbranch_scc1 L_w0_56
    v_mov_b32 v14, s62
    v_mov_b32 v15, 0
    s_lshl_b32 s21, s19, 7
    s_add_u32 s21, s21, 25296896
    s_mov_b64 exec, 1
    buffer_store_dword v14, v15, s[8:11], s21 offen sc1
    s_mov_b64 exec, -1
L_w0_56:
    s_waitcnt lgkmcnt(4)
    v_mfma_f32_16x16x32_bf16 v[48:51], v[152:155], v[32:35], v[48:51]
    v_mfma_f32_16x16x32_bf16 v[64:67], v[156:159], v[32:35], v[64:67]
    ds_read_b128 v[32:35], v3 offset:9216
    v_mfma_f32_16x16x32_bf16 v[52:55], v[152:155], v[36:39], v[52:55]
    v_mfma_f32_16x16x32_bf16 v[68:71], v[156:159], v[36:39], v[68:71]
    ds_read_b128 v[36:39], v3 offset:25600
    s_add_u32 s21, s28, 6144
    buffer_load_dwordx4 v[144:147], v2, s[8:11], s21 offen sc1
    v_mfma_f32_16x16x32_bf16 v[56:59], v[152:155], v[40:43], v[56:59]
    v_mfma_f32_16x16x32_bf16 v[72:75], v[156:159], v[40:43], v[72:75]
    ds_read_b128 v[40:43], v3 offset:41984
    v_mfma_f32_16x16x32_bf16 v[60:63], v[152:155], v[44:47], v[60:63]
    v_mfma_f32_16x16x32_bf16 v[76:79], v[156:159], v[44:47], v[76:79]
    ds_read_b128 v[44:47], v3 offset:58368
    s_add_u32 s21, s29, 6144
    buffer_load_dwordx4 v[148:151], v2, s[8:11], s21 offen sc1
    s_waitcnt lgkmcnt(4)
    v_mfma_f32_16x16x32_bf16 v[48:51], v[160:163], v[16:19], v[48:51]
    v_mfma_f32_16x16x32_bf16 v[64:67], v[164:167], v[16:19], v[64:67]
    ds_read_b128 v[16:19], v3 offset:10240
    v_mfma_f32_16x16x32_bf16 v[52:55], v[160:163], v[20:23], v[52:55]
    v_mfma_f32_16x16x32_bf16 v[68:71], v[164:167], v[20:23], v[68:71]
    ds_read_b128 v[20:23], v3 offset:26624
    s_add_u32 s21, s28, 7168
    buffer_load_dwordx4 v[152:155], v2, s[8:11], s21 offen sc1
    v_mfma_f32_16x16x32_bf16 v[56:59], v[160:163], v[24:27], v[56:59]
    v_mfma_f32_16x16x32_bf16 v[72:75], v[164:167], v[24:27], v[72:75]
    ds_read_b128 v[24:27], v3 offset:43008
    v_mfma_f32_16x16x32_bf16 v[60:63], v[160:163], v[28:31], v[60:63]
    v_mfma_f32_16x16x32_bf16 v[76:79], v[164:167], v[28:31], v[76:79]
    ds_read_b128 v[28:31], v3 offset:59392
    s_add_u32 s21, s29, 7168
    buffer_load_dwordx4 v[156:159], v2, s[8:11], s21 offen sc1
    s_waitcnt lgkmcnt(4)
    v_mfma_f32_16x16x32_bf16 v[48:51], v[168:171], v[32:35], v[48:51]
    v_mfma_f32_16x16x32_bf16 v[64:67], v[172:175], v[32:35], v[64:67]
    ds_read_b128 v[32:35], v3 offset:11264
    v_mfma_f32_16x16x32_bf16 v[52:55], v[168:171], v[36:39], v[52:55]
    v_mfma_f32_16x16x32_bf16 v[68:71], v[172:175], v[36:39], v[68:71]
    ds_read_b128 v[36:39], v3 offset:27648
    s_add_u32 s21, s28, 8192
    buffer_load_dwordx4 v[160:163], v2, s[8:11], s21 offen sc1
    v_mfma_f32_16x16x32_bf16 v[56:59], v[168:171], v[40:43], v[56:59]
    v_mfma_f32_16x16x32_bf16 v[72:75], v[172:175], v[40:43], v[72:75]
    ds_read_b128 v[40:43], v3 offset:44032
    v_mfma_f32_16x16x32_bf16 v[60:63], v[168:171], v[44:47], v[60:63]
    v_mfma_f32_16x16x32_bf16 v[76:79], v[172:175], v[44:47], v[76:79]
    ds_read_b128 v[44:47], v3 offset:60416
    s_add_u32 s21, s29, 8192
    buffer_load_dwordx4 v[164:167], v2, s[8:11], s21 offen sc1
    s_waitcnt lgkmcnt(4)
    v_mfma_f32_16x16x32_bf16 v[48:51], v[176:179], v[16:19], v[48:51]
    v_mfma_f32_16x16x32_bf16 v[64:67], v[180:183], v[16:19], v[64:67]
    ds_read_b128 v[16:19], v3 offset:12288
    v_mfma_f32_16x16x32_bf16 v[52:55], v[176:179], v[20:23], v[52:55]
    v_mfma_f32_16x16x32_bf16 v[68:71], v[180:183], v[20:23], v[68:71]
    ds_read_b128 v[20:23], v3 offset:28672
    s_add_u32 s21, s28, 9216
    buffer_load_dwordx4 v[168:171], v2, s[8:11], s21 offen sc1
    v_mfma_f32_16x16x32_bf16 v[56:59], v[176:179], v[24:27], v[56:59]
    v_mfma_f32_16x16x32_bf16 v[72:75], v[180:183], v[24:27], v[72:75]
    ds_read_b128 v[24:27], v3 offset:45056
    v_mfma_f32_16x16x32_bf16 v[60:63], v[176:179], v[28:31], v[60:63]
    v_mfma_f32_16x16x32_bf16 v[76:79], v[180:183], v[28:31], v[76:79]
    ds_read_b128 v[28:31], v3 offset:61440
    s_waitcnt lgkmcnt(4)
    v_mfma_f32_16x16x32_bf16 v[48:51], v[184:187], v[32:35], v[48:51]
    v_mfma_f32_16x16x32_bf16 v[64:67], v[188:191], v[32:35], v[64:67]
    ds_read_b128 v[32:35], v3 offset:13312
    v_mfma_f32_16x16x32_bf16 v[52:55], v[184:187], v[36:39], v[52:55]
    v_mfma_f32_16x16x32_bf16 v[68:71], v[188:191], v[36:39], v[68:71]
    ds_read_b128 v[36:39], v3 offset:29696
    v_mfma_f32_16x16x32_bf16 v[56:59], v[184:187], v[40:43], v[56:59]
    v_mfma_f32_16x16x32_bf16 v[72:75], v[188:191], v[40:43], v[72:75]
    ds_read_b128 v[40:43], v3 offset:46080
    v_mfma_f32_16x16x32_bf16 v[60:63], v[184:187], v[44:47], v[60:63]
    v_mfma_f32_16x16x32_bf16 v[76:79], v[188:191], v[44:47], v[76:79]
    ds_read_b128 v[44:47], v3 offset:62464
    s_lshl_b32 s36, s22, 4
    s_lshl_b32 s23, s16, 1
    s_add_u32 s36, s36, s23
    s_lshl_b32 s36, s36, 7
    v_lshlrev_b32 v13, 7, v1
    s_add_u32 s21, s36, 25296896
    s_mov_b64 exec, 0x3
    buffer_load_dword v12, v13, s[8:11], s21 offen sc1
    s_mov_b64 exec, -1
    s_waitcnt lgkmcnt(4)
    v_mfma_f32_16x16x32_bf16 v[48:51], v[192:195], v[16:19], v[48:51]
    v_mfma_f32_16x16x32_bf16 v[64:67], v[196:199], v[16:19], v[64:67]
    ds_read_b128 v[16:19], v3 offset:14336
    v_mfma_f32_16x16x32_bf16 v[52:55], v[192:195], v[20:23], v[52:55]
    v_mfma_f32_16x16x32_bf16 v[68:71], v[196:199], v[20:23], v[68:71]
    ds_read_b128 v[20:23], v3 offset:30720
    v_mfma_f32_16x16x32_bf16 v[56:59], v[192:195], v[24:27], v[56:59]
    v_mfma_f32_16x16x32_bf16 v[72:75], v[196:199], v[24:27], v[72:75]
    ds_read_b128 v[24:27], v3 offset:47104
    v_mfma_f32_16x16x32_bf16 v[60:63], v[192:195], v[28:31], v[60:63]
    v_mfma_f32_16x16x32_bf16 v[76:79], v[196:199], v[28:31], v[76:79]
    ds_read_b128 v[28:31], v3 offset:63488
    s_waitcnt lgkmcnt(4)
    v_mfma_f32_16x16x32_bf16 v[48:51], v[200:203], v[32:35], v[48:51]
    v_mfma_f32_16x16x32_bf16 v[64:67], v[204:207], v[32:35], v[64:67]
    ds_read_b128 v[32:35], v3 offset:15360
    v_mfma_f32_16x16x32_bf16 v[52:55], v[200:203], v[36:39], v[52:55]
    v_mfma_f32_16x16x32_bf16 v[68:71], v[204:207], v[36:39], v[68:71]
    ds_read_b128 v[36:39], v3 offset:31744
    v_mfma_f32_16x16x32_bf16 v[56:59], v[200:203], v[40:43], v[56:59]
    v_mfma_f32_16x16x32_bf16 v[72:75], v[204:207], v[40:43], v[72:75]
    ds_read_b128 v[40:43], v3 offset:48128
    v_mfma_f32_16x16x32_bf16 v[60:63], v[200:203], v[44:47], v[60:63]
    v_mfma_f32_16x16x32_bf16 v[76:79], v[204:207], v[44:47], v[76:79]
    ds_read_b128 v[44:47], v3 offset:64512
    s_mov_b32 s23, 0
    s_waitcnt vmcnt(0)
L_fc_57:
    s_mov_b64 exec, 0x3
    v_cmp_ne_u32 vcc, s62, v12
    s_mov_b64 exec, -1
    s_add_u32 s23, s23, 1
    s_cmp_gt_u32 s23, 200000
    s_cbranch_scc1 L_fcd_58
    s_cbranch_vccz L_fcd_58
    v_lshlrev_b32 v13, 7, v1
    s_add_u32 s21, s36, 25296896
    s_mov_b64 exec, 0x3
    buffer_load_dword v12, v13, s[8:11], s21 offen sc1
    s_mov_b64 exec, -1
    s_waitcnt vmcnt(0)
    s_branch L_fc_57
L_fcd_58:
    s_mul_i32 s21, s17, 224
    s_mul_i32 s23, s16, 14
    s_add_u32 s21, s21, s23
    s_lshl_b32 s21, s21, 10
    s_add_u32 s37, s21, 16777216
    s_waitcnt lgkmcnt(4)
    v_mfma_f32_16x16x32_bf16 v[48:51], v[208:211], v[16:19], v[48:51]
    v_mfma_f32_16x16x32_bf16 v[64:67], v[212:215], v[16:19], v[64:67]
    s_add_u32 s21, s37, 8192
    buffer_load_dwordx4 v[172:175], v2, s[8:11], s21 offen offset:0 sc1
    v_mfma_f32_16x16x32_bf16 v[52:55], v[208:211], v[20:23], v[52:55]
    v_mfma_f32_16x16x32_bf16 v[68:71], v[212:215], v[20:23], v[68:71]
    s_add_u32 s21, s37, 8192
    buffer_load_dwordx4 v[176:179], v2, s[8:11], s21 offen offset:1024 sc1
    v_mfma_f32_16x16x32_bf16 v[56:59], v[208:211], v[24:27], v[56:59]
    v_mfma_f32_16x16x32_bf16 v[72:75], v[212:215], v[24:27], v[72:75]
    s_add_u32 s21, s37, 8192
    buffer_load_dwordx4 v[180:183], v2, s[8:11], s21 offen offset:2048 sc1
    v_mfma_f32_16x16x32_bf16 v[60:63], v[208:211], v[28:31], v[60:63]
    v_mfma_f32_16x16x32_bf16 v[76:79], v[212:215], v[28:31], v[76:79]
    s_waitcnt lgkmcnt(0)
    v_mfma_f32_16x16x32_bf16 v[48:51], v[216:219], v[32:35], v[48:51]
    v_mfma_f32_16x16x32_bf16 v[64:67], v[220:223], v[32:35], v[64:67]
    s_add_u32 s21, s37, 8192
    buffer_load_dwordx4 v[184:187], v2, s[8:11], s21 offen offset:3072 sc1
    v_mfma_f32_16x16x32_bf16 v[52:55], v[216:219], v[36:39], v[52:55]
    v_mfma_f32_16x16x32_bf16 v[68:71], v[220:223], v[36:39], v[68:71]
    s_add_u32 s21, s37, 12288
    buffer_load_dwordx4 v[188:191], v2, s[8:11], s21 offen offset:0 sc1
    v_mfma_f32_16x16x32_bf16 v[56:59], v[216:219], v[40:43], v[56:59]
    v_mfma_f32_16x16x32_bf16 v[72:75], v[220:223], v[40:43], v[72:75]
    s_add_u32 s21, s37, 12288
    buffer_load_dwordx4 v[192:195], v2, s[8:11], s21 offen offset:1024 sc1
    v_mfma_f32_16x16x32_bf16 v[60:63], v[216:219], v[44:47], v[60:63]
    v_mfma_f32_16x16x32_bf16 v[76:79], v[220:223], v[44:47], v[76:79]
    s_branch L_gu2_mk
L_w7_mk:
    s_lshl_b32 s38, s22, 11
    s_add_u32 s21, s38, 25231360
    v_lshlrev_b32 v13, 7, v1
    s_add_u32 s101, s21, 262144
    s_mov_b32 s23, 0
    s_mov_b32 s100, 0
    s_mov_b32 exec_lo, 0xffff
    s_mov_b32 exec_hi, 0
L_polld_59:
    buffer_load_dword v12, v13, s[8:11], s101 offen sc1
    s_waitcnt vmcnt(0)
    v_cmp_eq_u32 vcc, s62, v12
    s_nop 3
    s_or_b32 s100, s100, vcc_lo
    s_cmp_eq_u32 s100, 65535
    s_cbranch_scc1 L_pddone_60
    buffer_load_dword v12, v13, s[8:11], s101 offen sc1
    s_waitcnt vmcnt(0)
    v_cmp_eq_u32 vcc, s62, v12
    s_nop 3
    s_or_b32 s100, s100, vcc_lo
    s_cmp_eq_u32 s100, 65535
    s_cbranch_scc1 L_pddone_60
    buffer_load_dword v12, v13, s[8:11], s101 offen sc1
    s_waitcnt vmcnt(0)
    v_cmp_eq_u32 vcc, s62, v12
    s_nop 3
    s_or_b32 s100, s100, vcc_lo
    s_cmp_eq_u32 s100, 65535
    s_cbranch_scc1 L_pddone_60
    buffer_load_dword v12, v13, s[8:11], s21 offen sc1
    s_add_u32 s23, s23, 1
    s_waitcnt vmcnt(0)
    v_cmp_eq_u32 vcc, s62, v12
    s_nop 3
    s_or_b32 s100, s100, vcc_lo
    s_cmp_eq_u32 s100, 65535
    s_cbranch_scc1 L_pddone_60
    s_cmp_gt_u32 s23, 200000
    s_cbranch_scc0 L_polld_59
L_pddone_60:
    s_mov_b64 exec, -1
    s_mov_b32 s34, 989855744
    s_mov_b32 s35, 925353388
    s_mov_b32 m0, s24
    s_add_u32 s24, s24, 2048
    buffer_load_dwordx4 v2, s[8:11], s37 offen sc1 lds
    s_add_u32 s37, s37, 2048
    s_mov_b32 m0, s24
    s_add_u32 s24, s24, 2048
    buffer_load_dwordx4 v2, s[8:11], s37 offen sc1 lds
    s_add_u32 s37, s37, 2048
    s_mov_b32 m0, s24
    s_add_u32 s24, s24, 2048
    buffer_load_dwordx4 v2, s[8:11], s37 offen sc1 lds
    s_add_u32 s37, s37, 2048
    s_mov_b32 m0, s24
    s_add_u32 s24, s24, 2048
    buffer_load_dwordx4 v2, s[8:11], s37 offen sc1 lds
    s_add_u32 s37, s37, 2048
    s_mov_b32 m0, s24
    s_add_u32 s24, s24, 2048
    buffer_load_dwordx4 v2, s[8:11], s37 offen sc1 lds
    s_add_u32 s37, s37, 2048
    s_lshl_b32 s27, s22, 10
    s_add_u32 s27, s27, 6553600
    buffer_load_dwordx4 v[16:19], v2, s[8:11], s27 offen sc1
    s_add_u32 s27, s27, 16384
    buffer_load_dwordx4 v[20:23], v2, s[8:11], s27 offen sc1
    s_add_u32 s27, s27, 16384
    buffer_load_dwordx4 v[24:27], v2, s[8:11], s27 offen sc1
    s_add_u32 s27, s27, 16384
    buffer_load_dwordx4 v[28:31], v2, s[8:11], s27 offen sc1
    s_add_u32 s27, s27, 16384
    buffer_load_dwordx4 v[32:35], v2, s[8:11], s27 offen sc1
    s_add_u32 s27, s27, 16384
    buffer_load_dwordx4 v[36:39], v2, s[8:11], s27 offen sc1
    s_add_u32 s27, s27, 16384
    buffer_load_dwordx4 v[40:43], v2, s[8:11], s27 offen sc1
    s_add_u32 s27, s27, 16384
    buffer_load_dwordx4 v[44:47], v2, s[8:11], s27 offen sc1
    s_barrier
    s_waitcnt vmcnt(0)
    v_add_f32 v16, v16, v20
    v_add_f32 v17, v17, v21
    v_add_f32 v18, v18, v22
    v_add_f32 v19, v19, v23
    v_add_f32 v16, v16, v24
    v_add_f32 v17, v17, v25
    v_add_f32 v18, v18, v26
    v_add_f32 v19, v19, v27
    v_add_f32 v16, v16, v28
    v_add_f32 v17, v17, v29
    v_add_f32 v18, v18, v30
    v_add_f32 v19, v19, v31
    v_add_f32 v16, v16, v32
    v_add_f32 v17, v17, v33
    v_add_f32 v18, v18, v34
    v_add_f32 v19, v19, v35
    v_add_f32 v16, v16, v36
    v_add_f32 v17, v17, v37
    v_add_f32 v18, v18, v38
    v_add_f32 v19, v19, v39
    v_add_f32 v16, v16, v40
    v_add_f32 v17, v17, v41
    v_add_f32 v18, v18, v42
    v_add_f32 v19, v19, v43
    v_add_f32 v16, v16, v44
    v_add_f32 v17, v17, v45
    v_add_f32 v18, v18, v46
    v_add_f32 v19, v19, v47
    v_mul_f32 v16, s34, v16
    v_mul_f32 v17, s34, v17
    v_fma_f32 v17, -v16, v16, v17
    v_max_f32 v17, 0, v17
    v_add_f32 v17, s35, v17
    v_rcp_f32 v17, v17
    v_mul_f32 v18, s34, v18
    v_mul_f32 v19, s34, v19
    v_fma_f32 v19, -v18, v18, v19
    v_max_f32 v19, 0, v19
    v_add_f32 v19, s35, v19
    v_rcp_f32 v19, v19
    v_add_u32 v9, 147456, v2
    s_mov_b32 exec_lo, 0x0000ffff
    s_mov_b32 exec_hi, 0x0000ffff
    ds_write_b128 v9, v[16:19]
    s_mov_b64 exec, -1
    v_mov_b32 v80, v172
    v_mov_b32 v81, v173
    v_mov_b32 v82, v174
    v_mov_b32 v83, v175
    v_mov_b32 v84, v176
    v_mov_b32 v85, v177
    v_mov_b32 v86, v178
    v_mov_b32 v87, v179
    v_mov_b32 v88, v180
    v_mov_b32 v89, v181
    v_mov_b32 v90, v182
    v_mov_b32 v91, v183
    v_mov_b32 v224, v184
    v_mov_b32 v225, v185
    v_mov_b32 v226, v186
    v_mov_b32 v227, v187
    v_mov_b32 v228, v188
    v_mov_b32 v229, v189
    v_mov_b32 v230, v190
    v_mov_b32 v231, v191
    v_mov_b32 v232, v192
    v_mov_b32 v233, v193
    v_mov_b32 v234, v194
    v_mov_b32 v235, v195
    v_mov_b32 v236, v196
    v_mov_b32 v237, v197
    v_mov_b32 v238, v198
    v_mov_b32 v239, v199
    v_mov_b32 v240, v200
    v_mov_b32 v241, v201
    v_mov_b32 v242, v202
    v_mov_b32 v243, v203
    v_mov_b32 v252, v204
    v_mov_b32 v253, v205
    v_mov_b32 v254, v206
    v_mov_b32 v255, v207
    s_waitcnt lgkmcnt(0)
    s_barrier
    s_barrier
    s_add_u32 s21, s38, 25264128
    s_mov_b32 s23, 0
    s_mov_b64 exec, 0xffff
L_poll_62:
    buffer_load_dword v12, v13, s[8:11], s21 offen sc1
    s_add_u32 s23, s23, 1
    s_waitcnt vmcnt(0)
    v_cmp_ne_u32 vcc, s62, v12
    s_cmp_gt_u32 s23, 200000
    s_cbranch_scc1 L_pdone_63
    s_cbranch_vccnz L_poll_62
L_pdone_63:
    s_mov_b64 exec, -1
    s_lshr_b32 s23, s16, 2
    s_add_u32 s23, s23, 0
    s_lshl_b32 s23, s23, 10
    s_add_u32 s37, s40, s23
    s_add_u32 s24, s41, s23
    s_add_u32 s37, s37, 32768
    s_add_u32 s24, s24, 65536
    s_mov_b32 m0, s24
    s_add_u32 s24, s24, 2048
    buffer_load_dwordx4 v2, s[8:11], s37 offen sc1 lds
    s_add_u32 s37, s37, 2048
    s_mov_b32 m0, s24
    s_add_u32 s24, s24, 2048
    buffer_load_dwordx4 v2, s[8:11], s37 offen sc1 lds
    s_add_u32 s37, s37, 2048
    s_mov_b32 m0, s24
    s_add_u32 s24, s24, 2048
    buffer_load_dwordx4 v2, s[8:11], s37 offen sc1 lds
    s_add_u32 s37, s37, 2048
    s_mov_b32 m0, s24
    s_add_u32 s24, s24, 2048
    buffer_load_dwordx4 v2, s[8:11], s37 offen sc1 lds
    s_add_u32 s37, s37, 2048
    s_mov_b32 m0, s24
    s_add_u32 s24, s24, 2048
    buffer_load_dwordx4 v2, s[8:11], s37 offen sc1 lds
    s_add_u32 s37, s37, 2048
    s_mov_b32 m0, s24
    s_add_u32 s24, s24, 2048
    buffer_load_dwordx4 v2, s[8:11], s37 offen sc1 lds
    s_add_u32 s37, s37, 2048
    s_mov_b32 m0, s24
    s_add_u32 s24, s24, 2048
    buffer_load_dwordx4 v2, s[8:11], s37 offen sc1 lds
    s_add_u32 s37, s37, 2048
    s_mov_b32 m0, s24
    s_add_u32 s24, s24, 2048
    buffer_load_dwordx4 v2, s[8:11], s37 offen sc1 lds
    s_add_u32 s37, s37, 2048
    s_lshl_b32 s27, s22, 10
    s_add_u32 s27, s27, 6553600
    buffer_load_dwordx4 v[16:19], v2, s[8:11], s27 offen sc1
    s_add_u32 s27, s27, 16384
    buffer_load_dwordx4 v[20:23], v2, s[8:11], s27 offen sc1
    s_add_u32 s27, s27, 16384
    buffer_load_dwordx4 v[24:27], v2, s[8:11], s27 offen sc1
    s_add_u32 s27, s27, 16384
    buffer_load_dwordx4 v[28:31], v2, s[8:11], s27 offen sc1
    s_add_u32 s27, s27, 16384
    buffer_load_dwordx4 v[32:35], v2, s[8:11], s27 offen sc1
    s_add_u32 s27, s27, 16384
    buffer_load_dwordx4 v[36:39], v2, s[8:11], s27 offen sc1
    s_add_u32 s27, s27, 16384
    buffer_load_dwordx4 v[40:43], v2, s[8:11], s27 offen sc1
    s_add_u32 s27, s27, 16384
    buffer_load_dwordx4 v[44:47], v2, s[8:11], s27 offen sc1
    s_waitcnt vmcnt(0)
    v_add_f32 v16, v16, v20
    v_add_f32 v17, v17, v21
    v_add_f32 v18, v18, v22
    v_add_f32 v19, v19, v23
    v_add_f32 v16, v16, v24
    v_add_f32 v17, v17, v25
    v_add_f32 v18, v18, v26
    v_add_f32 v19, v19, v27
    v_add_f32 v16, v16, v28
    v_add_f32 v17, v17, v29
    v_add_f32 v18, v18, v30
    v_add_f32 v19, v19, v31
    v_add_f32 v16, v16, v32
    v_add_f32 v17, v17, v33
    v_add_f32 v18, v18, v34
    v_add_f32 v19, v19, v35
    v_add_f32 v16, v16, v36
    v_add_f32 v17, v17, v37
    v_add_f32 v18, v18, v38
    v_add_f32 v19, v19, v39
    v_add_f32 v16, v16, v40
    v_add_f32 v17, v17, v41
    v_add_f32 v18, v18, v42
    v_add_f32 v19, v19, v43
    v_add_f32 v16, v16, v44
    v_add_f32 v17, v17, v45
    v_add_f32 v18, v18, v46
    v_add_f32 v19, v19, v47
    v_mul_f32 v16, s34, v16
    v_mul_f32 v17, s34, v17
    v_fma_f32 v17, -v16, v16, v17
    v_max_f32 v17, 0, v17
    v_add_f32 v17, s35, v17
    v_rcp_f32 v17, v17
    v_mul_f32 v18, s34, v18
    v_mul_f32 v19, s34, v19
    v_fma_f32 v19, -v18, v18, v19
    v_max_f32 v19, 0, v19
    v_add_f32 v19, s35, v19
    v_rcp_f32 v19, v19
    v_add_u32 v9, 147456, v2
    s_mov_b32 exec_lo, 0xffff0000
    s_mov_b32 exec_hi, 0xffff0000
    ds_write_b128 v9, v[16:19]
    s_mov_b64 exec, -1
    s_waitcnt lgkmcnt(0)
    s_barrier
    s_barrier
    s_lshl_b32 s36, s22, 4
    s_lshl_b32 s23, s16, 1
    s_add_u32 s36, s36, s23
    s_lshl_b32 s36, s36, 7
    v_lshlrev_b32 v13, 7, v1
    s_add_u32 s21, s36, 25296896
    s_mov_b64 exec, 0x3
    buffer_load_dword v12, v13, s[8:11], s21 offen sc1
    s_mov_b64 exec, -1
    s_mov_b32 s23, 0
    s_waitcnt vmcnt(0)
L_fc_64:
    s_mov_b64 exec, 0x3
    v_cmp_ne_u32 vcc, s62, v12
    s_mov_b64 exec, -1
    s_add_u32 s23, s23, 1
    s_cmp_gt_u32 s23, 200000
    s_cbranch_scc1 L_fcd_65
    s_cbranch_vccz L_fcd_65
    v_lshlrev_b32 v13, 7, v1
    s_add_u32 s21, s36, 25296896
    s_mov_b64 exec, 0x3
    buffer_load_dword v12, v13, s[8:11], s21 offen sc1
    s_mov_b64 exec, -1
    s_waitcnt vmcnt(0)
    s_branch L_fc_64
L_fcd_65:
    s_mul_i32 s21, s17, 224
    s_mul_i32 s23, s16, 14
    s_add_u32 s21, s21, s23
    s_lshl_b32 s21, s21, 10
    s_add_u32 s37, s21, 16777216
    s_add_u32 s21, s37, 8192
    buffer_load_dwordx4 v[172:175], v2, s[8:11], s21 offen offset:0 sc1
    s_add_u32 s21, s37, 8192
    buffer_load_dwordx4 v[176:179], v2, s[8:11], s21 offen offset:1024 sc1
    s_add_u32 s21, s37, 8192
    buffer_load_dwordx4 v[180:183], v2, s[8:11], s21 offen offset:2048 sc1
    s_add_u32 s21, s37, 8192
    buffer_load_dwordx4 v[184:187], v2, s[8:11], s21 offen offset:3072 sc1
    s_add_u32 s21, s37, 12288
    buffer_load_dwordx4 v[188:191], v2, s[8:11], s21 offen offset:0 sc1
    s_add_u32 s21, s37, 12288
    buffer_load_dwordx4 v[192:195], v2, s[8:11], s21 offen offset:1024 sc1
L_gu2_mk:
    s_add_u32 s21, s37, 0
    buffer_load_dwordx4 v[16:19], v2, s[8:11], s21 offen offset:0 sc1
    s_add_u32 s21, s37, 0
    buffer_load_dwordx4 v[20:23], v2, s[8:11], s21 offen offset:1024 sc1
    s_add_u32 s21, s37, 0
    buffer_load_dwordx4 v[24:27], v2, s[8:11], s21 offen offset:2048 sc1
    s_add_u32 s21, s37, 0
    buffer_load_dwordx4 v[28:31], v2, s[8:11], s21 offen offset:3072 sc1
    s_add_u32 s21, s37, 4096
    buffer_load_dwordx4 v[32:35], v2, s[8:11], s21 offen offset:0 sc1
    s_add_u32 s21, s37, 4096
    buffer_load_dwordx4 v[36:39], v2, s[8:11], s21 offen offset:1024 sc1
    s_add_u32 s21, s37, 4096
    buffer_load_dwordx4 v[40:43], v2, s[8:11], s21 offen offset:2048 sc1
    s_add_u32 s21, s37, 4096
    buffer_load_dwordx4 v[44:47], v2, s[8:11], s21 offen offset:3072 sc1
    s_add_u32 s37, s37, 114688
    s_cmp_eq_u32 s16, 7
    s_cbranch_scc1 L_ne_66
    ds_read_b64 v[204:205], v9 offset:256
    ds_read_b64 v[206:207], v9 offset:384
    ds_read_b64 v[208:209], v9 offset:768
    ds_read_b64 v[210:211], v9 offset:896
    s_mul_i32 s21, s22, 448
    s_add_u32 s21, s21, s26
    s_add_u32 s21, s21, 112
    s_lshl_b32 s21, s21, 10
    s_add_u32 s21, s21, 16777216
    s_waitcnt lgkmcnt(0)
    v_fma_f32 v48, -v204, v244, v48
    v_fma_f32 v64, -v204, v248, v64
    v_fma_f32 v49, -v204, v245, v49
    v_fma_f32 v65, -v204, v249, v65
    v_fma_f32 v50, -v204, v246, v50
    v_fma_f32 v66, -v204, v250, v66
    v_fma_f32 v51, -v204, v247, v51
    v_fma_f32 v67, -v204, v251, v67
    v_max_f32 v48, 0, v48
    v_mul_f32 v64, v64, v205
    v_max_f32 v49, 0, v49
    v_mul_f32 v65, v65, v205
    v_max_f32 v50, 0, v50
    v_mul_f32 v66, v66, v205
    v_max_f32 v51, 0, v51
    v_mul_f32 v67, v67, v205
    v_mul_f32 v48, v48, v64
    v_mul_f32 v49, v49, v65
    v_mul_f32 v50, v50, v66
    v_mul_f32 v51, v51, v67
    v_cvt_pk_bf16_f32 v48, v48, v49
    v_cvt_pk_bf16_f32 v49, v50, v51
    v_fma_f32 v52, -v206, v244, v52
    v_fma_f32 v68, -v206, v248, v68
    v_fma_f32 v53, -v206, v245, v53
    v_fma_f32 v69, -v206, v249, v69
    v_fma_f32 v54, -v206, v246, v54
    v_fma_f32 v70, -v206, v250, v70
    v_fma_f32 v55, -v206, v247, v55
    v_fma_f32 v71, -v206, v251, v71
    v_max_f32 v52, 0, v52
    v_mul_f32 v68, v68, v207
    v_max_f32 v53, 0, v53
    v_mul_f32 v69, v69, v207
    v_max_f32 v54, 0, v54
    v_mul_f32 v70, v70, v207
    v_max_f32 v55, 0, v55
    v_mul_f32 v71, v71, v207
    v_mul_f32 v52, v52, v68
    v_mul_f32 v53, v53, v69
    v_mul_f32 v54, v54, v70
    v_mul_f32 v55, v55, v71
    v_cvt_pk_bf16_f32 v50, v52, v53
    v_cvt_pk_bf16_f32 v51, v54, v55
    s_nop 1
    v_permlane16_swap_b32 v48, v50
    v_permlane16_swap_b32 v49, v51
    buffer_store_dwordx4 v[48:51], v2, s[8:11], s21 offen sc1
    s_add_u32 s21, s21, 229376
    v_fma_f32 v56, -v208, v244, v56
    v_fma_f32 v72, -v208, v248, v72
    v_fma_f32 v57, -v208, v245, v57
    v_fma_f32 v73, -v208, v249, v73
    v_fma_f32 v58, -v208, v246, v58
    v_fma_f32 v74, -v208, v250, v74
    v_fma_f32 v59, -v208, v247, v59
    v_fma_f32 v75, -v208, v251, v75
    v_max_f32 v56, 0, v56
    v_mul_f32 v72, v72, v209
    v_max_f32 v57, 0, v57
    v_mul_f32 v73, v73, v209
    v_max_f32 v58, 0, v58
    v_mul_f32 v74, v74, v209
    v_max_f32 v59, 0, v59
    v_mul_f32 v75, v75, v209
    v_mul_f32 v56, v56, v72
    v_mul_f32 v57, v57, v73
    v_mul_f32 v58, v58, v74
    v_mul_f32 v59, v59, v75
    v_cvt_pk_bf16_f32 v56, v56, v57
    v_cvt_pk_bf16_f32 v57, v58, v59
    v_fma_f32 v60, -v210, v244, v60
    v_fma_f32 v76, -v210, v248, v76
    v_fma_f32 v61, -v210, v245, v61
    v_fma_f32 v77, -v210, v249, v77
    v_fma_f32 v62, -v210, v246, v62
    v_fma_f32 v78, -v210, v250, v78
    v_fma_f32 v63, -v210, v247, v63
    v_fma_f32 v79, -v210, v251, v79
    v_max_f32 v60, 0, v60
    v_mul_f32 v76, v76, v211
    v_max_f32 v61, 0, v61
    v_mul_f32 v77, v77, v211
    v_max_f32 v62, 0, v62
    v_mul_f32 v78, v78, v211
    v_max_f32 v63, 0, v63
    v_mul_f32 v79, v79, v211
    v_mul_f32 v60, v60, v76
    v_mul_f32 v61, v61, v77
    v_mul_f32 v62, v62, v78
    v_mul_f32 v63, v63, v79
    v_cvt_pk_bf16_f32 v58, v60, v61
    v_cvt_pk_bf16_f32 v59, v62, v63
    s_nop 1
    v_permlane16_swap_b32 v56, v58
    v_permlane16_swap_b32 v57, v59
    buffer_store_dwordx4 v[56:59], v2, s[8:11], s21 offen sc1
    s_waitcnt vmcnt(2)
    s_branch L_me_67
L_ne_66:
    s_waitcnt vmcnt(0)
L_me_67:
    v_mfma_f32_32x32x16_bf16 v[48:63], v[96:99], v[16:19], 0
    v_mfma_f32_32x32x16_bf16 v[64:79], v[100:103], v[16:19], 0
    v_mfma_f32_32x32x16_bf16 v[48:63], v[104:107], v[20:23], v[48:63]
    v_mfma_f32_32x32x16_bf16 v[64:79], v[108:111], v[20:23], v[64:79]
    v_mfma_f32_32x32x16_bf16 v[48:63], v[112:115], v[24:27], v[48:63]
    v_mfma_f32_32x32x16_bf16 v[64:79], v[116:119], v[24:27], v[64:79]
    v_mfma_f32_32x32x16_bf16 v[48:63], v[120:123], v[28:31], v[48:63]
    v_mfma_f32_32x32x16_bf16 v[64:79], v[124:127], v[28:31], v[64:79]
    v_mfma_f32_32x32x16_bf16 v[48:63], v[128:131], v[32:35], v[48:63]
    v_mfma_f32_32x32x16_bf16 v[64:79], v[132:135], v[32:35], v[64:79]
    v_mfma_f32_32x32x16_bf16 v[48:63], v[136:139], v[36:39], v[48:63]
    v_mfma_f32_32x32x16_bf16 v[64:79], v[140:143], v[36:39], v[64:79]
    v_mfma_f32_32x32x16_bf16 v[48:63], v[144:147], v[40:43], v[48:63]
    v_mfma_f32_32x32x16_bf16 v[64:79], v[148:151], v[40:43], v[64:79]
    v_mfma_f32_32x32x16_bf16 v[48:63], v[152:155], v[44:47], v[48:63]
    v_mfma_f32_32x32x16_bf16 v[64:79], v[156:159], v[44:47], v[64:79]
    v_mfma_f32_32x32x16_bf16 v[48:63], v[160:163], v[172:175], v[48:63]
    v_mfma_f32_32x32x16_bf16 v[64:79], v[164:167], v[172:175], v[64:79]
    v_mfma_f32_32x32x16_bf16 v[48:63], v[168:171], v[176:179], v[48:63]
    v_mfma_f32_32x32x16_bf16 v[64:79], v[80:83], v[176:179], v[64:79]
    v_mfma_f32_32x32x16_bf16 v[48:63], v[84:87], v[180:183], v[48:63]
    v_mfma_f32_32x32x16_bf16 v[64:79], v[88:91], v[180:183], v[64:79]
    v_mfma_f32_32x32x16_bf16 v[48:63], v[224:227], v[184:187], v[48:63]
    v_mfma_f32_32x32x16_bf16 v[64:79], v[228:231], v[184:187], v[64:79]
    v_mfma_f32_32x32x16_bf16 v[48:63], v[232:235], v[188:191], v[48:63]
    v_mfma_f32_32x32x16_bf16 v[64:79], v[236:239], v[188:191], v[64:79]
    v_mfma_f32_32x32x16_bf16 v[48:63], v[240:243], v[192:195], v[48:63]
    v_mfma_f32_32x32x16_bf16 v[64:79], v[252:255], v[192:195], v[64:79]
    s_waitcnt vmcnt(0)
    s_barrier
    s_cmp_lg_u32 s16, 0
    s_cbranch_scc1 L_w0_68
    v_mov_b32 v14, s62
    v_mov_b32 v15, 0
    s_lshl_b32 s21, s19, 7
    s_add_u32 s21, s21, 25329664
    s_mov_b64 exec, 1
    s_add_u32 s100, s21, 262144
    buffer_store_dword v14, v15, s[8:11], s100 offen
    buffer_store_dword v14, v15, s[8:11], s21 offen sc1
    s_mov_b64 exec, -1
L_w0_68:
    s_mul_i32 s21, s16, 9216
    s_add_u32 s21, s21, 0
    v_add_u32 v12, s21, v2
    s_nop 7
    s_nop 3
    ds_write_b128 v12, v[48:51] offset:0
    ds_write_b128 v12, v[52:55] offset:1152
    ds_write_b128 v12, v[56:59] offset:2304
    ds_write_b128 v12, v[60:63] offset:3456
    ds_write_b128 v12, v[64:67] offset:4608
    ds_write_b128 v12, v[68:71] offset:5760
    ds_write_b128 v12, v[72:75] offset:6912
    ds_write_b128 v12, v[76:79] offset:8064
    s_waitcnt lgkmcnt(0)
    s_barrier
    s_cmp_ge_u32 s16, 4
    s_cbranch_scc1 L_oA_69
    v_lshrrev_b32 v6, 3, v1
    v_mul_u32_u24 v14, 1152, v6
    s_and_b32 s21, s16, 3
    s_lshl_b32 s21, s21, 7
    s_add_u32 s21, s21, 0
    v_and_b32 v7, 7, v1
    v_lshl_add_u32 v14, v7, 4, v14
    v_add_u32 v14, s21, v14
    ds_read_b128 v[16:19], v14 offset:0
    ds_read_b128 v[20:23], v14 offset:512
    ds_read_b128 v[24:27], v14 offset:9216
    ds_read_b128 v[28:31], v14 offset:9728
    ds_read_b128 v[32:35], v14 offset:18432
    ds_read_b128 v[36:39], v14 offset:18944
    ds_read_b128 v[40:43], v14 offset:27648
    ds_read_b128 v[44:47], v14 offset:28160
    ds_read_b128 v[48:51], v14 offset:36864
    ds_read_b128 v[52:55], v14 offset:37376
    ds_read_b128 v[56:59], v14 offset:46080
    ds_read_b128 v[60:63], v14 offset:46592
    ds_read_b128 v[64:67], v14 offset:55296
    ds_read_b128 v[68:71], v14 offset:55808
    ds_read_b128 v[72:75], v14 offset:64512
    ds_read_b128 v[76:79], v14 offset:65024
    v_add_u32 v8, s25, v7
    v_lshlrev_b32 v9, 10, v8
    v_lshl_add_u32 v9, v6, 4, v9
    s_lshl_b32 s21, s18, 7
    v_add_u32 v9, s21, v9
    s_mov_b32 s12, s42
    s_and_b32 s13, s43, 0xffff
    s_mov_b32 s14, 2097152
    s_mov_b32 s15, 0x00020000
    v_lshlrev_b32 v204, 16, v92
    v_and_b32 v205, 0xffff0000, v92
    v_lshlrev_b32 v206, 16, v93
    v_and_b32 v207, 0xffff0000, v93
    v_lshlrev_b32 v208, 16, v94
    v_and_b32 v209, 0xffff0000, v94
    v_lshlrev_b32 v210, 16, v95
    v_and_b32 v211, 0xffff0000, v95
    s_waitcnt lgkmcnt(12)
    v_add_f32 v16, v16, v24
    v_add_f32 v17, v17, v25
    v_add_f32 v18, v18, v26
    v_add_f32 v19, v19, v27
    v_add_f32 v20, v20, v28
    v_add_f32 v21, v21, v29
    v_add_f32 v22, v22, v30
    v_add_f32 v23, v23, v31
    s_waitcnt lgkmcnt(10)
    v_add_f32 v16, v16, v32
    v_add_f32 v17, v17, v33
    v_add_f32 v18, v18, v34
    v_add_f32 v19, v19, v35
    v_add_f32 v20, v20, v36
    v_add_f32 v21, v21, v37
    v_add_f32 v22, v22, v38
    v_add_f32 v23, v23, v39
    s_waitcnt lgkmcnt(8)
    v_add_f32 v16, v16, v40
    v_add_f32 v17, v17, v41
    v_add_f32 v18, v18, v42
    v_add_f32 v19, v19, v43
    v_add_f32 v20, v20, v44
    v_add_f32 v21, v21, v45
    v_add_f32 v22, v22, v46
    v_add_f32 v23, v23, v47
    s_waitcnt lgkmcnt(6)
    v_add_f32 v16, v16, v48
    v_add_f32 v17, v17, v49
    v_add_f32 v18, v18, v50
    v_add_f32 v19, v19, v51
    v_add_f32 v20, v20, v52
    v_add_f32 v21, v21, v53
    v_add_f32 v22, v22, v54
    v_add_f32 v23, v23, v55
    s_waitcnt lgkmcnt(4)
    v_add_f32 v16, v16, v56
    v_add_f32 v17, v17, v57
    v_add_f32 v18, v18, v58
    v_add_f32 v19, v19, v59
    v_add_f32 v20, v20, v60
    v_add_f32 v21, v21, v61
    v_add_f32 v22, v22, v62
    v_add_f32 v23, v23, v63
    s_waitcnt lgkmcnt(2)
    v_add_f32 v16, v16, v64
    v_add_f32 v17, v17, v65
    v_add_f32 v18, v18, v66
    v_add_f32 v19, v19, v67
    v_add_f32 v20, v20, v68
    v_add_f32 v21, v21, v69
    v_add_f32 v22, v22, v70
    v_add_f32 v23, v23, v71
    s_waitcnt lgkmcnt(0)
    v_add_f32 v16, v16, v72
    v_add_f32 v17, v17, v73
    v_add_f32 v18, v18, v74
    v_add_f32 v19, v19, v75
    v_add_f32 v20, v20, v76
    v_add_f32 v21, v21, v77
    v_add_f32 v22, v22, v78
    v_add_f32 v23, v23, v79
    v_add_f32 v16, v16, v204
    v_add_f32 v17, v17, v205
    v_add_f32 v18, v18, v206
    v_add_f32 v19, v19, v207
    v_add_f32 v20, v20, v208
    v_add_f32 v21, v21, v209
    v_add_f32 v22, v22, v210
    v_add_f32 v23, v23, v211
    v_cvt_pk_bf16_f32 v24, v16, v17
    v_cvt_pk_bf16_f32 v25, v18, v19
    v_cvt_pk_bf16_f32 v26, v20, v21
    v_cvt_pk_bf16_f32 v27, v22, v23
    buffer_store_dwordx4 v[24:27], v9, s[12:15], 0 offen sc1
L_oA_69:
    s_lshl_b32 s21, s22, 4
    s_lshl_b32 s23, s16, 1
    s_add_u32 s21, s21, s23
    s_lshl_b32 s21, s21, 7
    s_add_u32 s21, s21, 25329664
    v_lshlrev_b32 v13, 7, v1
    s_add_u32 s101, s21, 262144
    s_mov_b32 s23, 0
    s_mov_b32 s100, 0
    s_mov_b32 exec_lo, 0x3
    s_mov_b32 exec_hi, 0
L_polld_70:
    buffer_load_dword v12, v13, s[8:11], s101 offen sc1
    s_waitcnt vmcnt(0)
    v_cmp_eq_u32 vcc, s62, v12
    s_nop 3
    s_or_b32 s100, s100, vcc_lo
    s_cmp_eq_u32 s100, 3
    s_cbranch_scc1 L_pddone_71
    buffer_load_dword v12, v13, s[8:11], s101 offen sc1
    s_waitcnt vmcnt(0)
    v_cmp_eq_u32 vcc, s62, v12
    s_nop 3
    s_or_b32 s100, s100, vcc_lo
    s_cmp_eq_u32 s100, 3
    s_cbranch_scc1 L_pddone_71
    buffer_load_dword v12, v13, s[8:11], s101 offen sc1
    s_waitcnt vmcnt(0)
    v_cmp_eq_u32 vcc, s62, v12
    s_nop 3
    s_or_b32 s100, s100, vcc_lo
    s_cmp_eq_u32 s100, 3
    s_cbranch_scc1 L_pddone_71
    buffer_load_dword v12, v13, s[8:11], s21 offen sc1
    s_add_u32 s23, s23, 1
    s_waitcnt vmcnt(0)
    v_cmp_eq_u32 vcc, s62, v12
    s_nop 3
    s_or_b32 s100, s100, vcc_lo
    s_cmp_eq_u32 s100, 3
    s_cbranch_scc1 L_pddone_71
    s_cmp_gt_u32 s23, 200000
    s_cbranch_scc0 L_polld_70
L_pddone_71:
    s_mov_b64 exec, -1
    buffer_load_dwordx4 v[16:19], v2, s[8:11], s37 offen offset:0 sc1
    buffer_load_dwordx4 v[20:23], v2, s[8:11], s37 offen offset:1024 sc1
    buffer_load_dwordx4 v[24:27], v2, s[8:11], s37 offen offset:2048 sc1
    buffer_load_dwordx4 v[28:31], v2, s[8:11], s37 offen offset:3072 sc1
    s_add_u32 s37, s37, 4096
    buffer_load_dwordx4 v[32:35], v2, s[8:11], s37 offen offset:0 sc1
    buffer_load_dwordx4 v[36:39], v2, s[8:11], s37 offen offset:1024 sc1
    buffer_load_dwordx4 v[40:43], v2, s[8:11], s37 offen offset:2048 sc1
    buffer_load_dwordx4 v[44:47], v2, s[8:11], s37 offen offset:3072 sc1
    s_add_u32 s37, s37, 4096
    s_waitcnt vmcnt(7)
    v_mfma_f32_32x32x16_bf16 v[172:187], v[96:99], v[16:19], 0
    v_mfma_f32_32x32x16_bf16 v[188:203], v[100:103], v[16:19], 0
    buffer_load_dwordx4 v[16:19], v2, s[8:11], s37 offen offset:0 sc1
    s_waitcnt vmcnt(7)
    v_mfma_f32_32x32x16_bf16 v[172:187], v[104:107], v[20:23], v[172:187]
    v_mfma_f32_32x32x16_bf16 v[188:203], v[108:111], v[20:23], v[188:203]
    buffer_load_dwordx4 v[20:23], v2, s[8:11], s37 offen offset:1024 sc1
    s_waitcnt vmcnt(7)
    v_mfma_f32_32x32x16_bf16 v[172:187], v[112:115], v[24:27], v[172:187]
    v_mfma_f32_32x32x16_bf16 v[188:203], v[116:119], v[24:27], v[188:203]
    buffer_load_dwordx4 v[24:27], v2, s[8:11], s37 offen offset:2048 sc1
    s_waitcnt vmcnt(7)
    v_mfma_f32_32x32x16_bf16 v[172:187], v[120:123], v[28:31], v[172:187]
    v_mfma_f32_32x32x16_bf16 v[188:203], v[124:127], v[28:31], v[188:203]
    buffer_load_dwordx4 v[28:31], v2, s[8:11], s37 offen offset:3072 sc1
    s_add_u32 s37, s37, 4096
    s_waitcnt vmcnt(7)
    v_mfma_f32_32x32x16_bf16 v[172:187], v[128:131], v[32:35], v[172:187]
    v_mfma_f32_32x32x16_bf16 v[188:203], v[132:135], v[32:35], v[188:203]
    buffer_load_dwordx4 v[32:35], v2, s[8:11], s37 offen offset:0 sc1
    s_waitcnt vmcnt(7)
    v_mfma_f32_32x32x16_bf16 v[172:187], v[136:139], v[36:39], v[172:187]
    v_mfma_f32_32x32x16_bf16 v[188:203], v[140:143], v[36:39], v[188:203]
    buffer_load_dwordx4 v[36:39], v2, s[8:11], s37 offen offset:1024 sc1
    s_waitcnt vmcnt(7)
    v_mfma_f32_32x32x16_bf16 v[172:187], v[144:147], v[40:43], v[172:187]
    v_mfma_f32_32x32x16_bf16 v[188:203], v[148:151], v[40:43], v[188:203]
    s_waitcnt vmcnt(6)
    v_mfma_f32_32x32x16_bf16 v[172:187], v[152:155], v[44:47], v[172:187]
    v_mfma_f32_32x32x16_bf16 v[188:203], v[156:159], v[44:47], v[188:203]
    s_waitcnt vmcnt(5)
    v_mfma_f32_32x32x16_bf16 v[172:187], v[160:163], v[16:19], v[172:187]
    v_mfma_f32_32x32x16_bf16 v[188:203], v[164:167], v[16:19], v[188:203]
    s_waitcnt vmcnt(4)
    v_mfma_f32_32x32x16_bf16 v[172:187], v[168:171], v[20:23], v[172:187]
    v_mfma_f32_32x32x16_bf16 v[188:203], v[80:83], v[20:23], v[188:203]
    s_waitcnt vmcnt(3)
    v_mfma_f32_32x32x16_bf16 v[172:187], v[84:87], v[24:27], v[172:187]
    v_mfma_f32_32x32x16_bf16 v[188:203], v[88:91], v[24:27], v[188:203]
    s_waitcnt vmcnt(2)
    v_mfma_f32_32x32x16_bf16 v[172:187], v[224:227], v[28:31], v[172:187]
    v_mfma_f32_32x32x16_bf16 v[188:203], v[228:231], v[28:31], v[188:203]
    s_waitcnt vmcnt(1)
    v_mfma_f32_32x32x16_bf16 v[172:187], v[232:235], v[32:35], v[172:187]
    v_mfma_f32_32x32x16_bf16 v[188:203], v[236:239], v[32:35], v[188:203]
    s_waitcnt vmcnt(0)
    v_mfma_f32_32x32x16_bf16 v[172:187], v[240:243], v[36:39], v[172:187]
    v_mfma_f32_32x32x16_bf16 v[188:203], v[252:255], v[36:39], v[188:203]
    s_mul_i32 s21, s16, 9216
    s_add_u32 s21, s21, 73728
    v_add_u32 v12, s21, v2
    s_nop 7
    s_nop 3
    ds_write_b128 v12, v[172:175] offset:0
    ds_write_b128 v12, v[176:179] offset:1152
    ds_write_b128 v12, v[180:183] offset:2304
    ds_write_b128 v12, v[184:187] offset:3456
    ds_write_b128 v12, v[188:191] offset:4608
    ds_write_b128 v12, v[192:195] offset:5760
    ds_write_b128 v12, v[196:199] offset:6912
    ds_write_b128 v12, v[200:203] offset:8064
    s_waitcnt lgkmcnt(0)
    s_barrier
    s_cmp_lt_u32 s16, 4
    s_cbranch_scc1 L_oB_73
    v_lshrrev_b32 v6, 3, v1
    v_mul_u32_u24 v14, 1152, v6
    s_and_b32 s21, s16, 3
    s_lshl_b32 s21, s21, 7
    s_add_u32 s21, s21, 73728
    v_and_b32 v7, 7, v1
    v_lshl_add_u32 v14, v7, 4, v14
    v_add_u32 v14, s21, v14
    ds_read_b128 v[16:19], v14 offset:0
    ds_read_b128 v[20:23], v14 offset:512
    ds_read_b128 v[24:27], v14 offset:9216
    ds_read_b128 v[28:31], v14 offset:9728
    ds_read_b128 v[32:35], v14 offset:18432
    ds_read_b128 v[36:39], v14 offset:18944
    ds_read_b128 v[40:43], v14 offset:27648
    ds_read_b128 v[44:47], v14 offset:28160
    ds_read_b128 v[48:51], v14 offset:36864
    ds_read_b128 v[52:55], v14 offset:37376
    ds_read_b128 v[56:59], v14 offset:46080
    ds_read_b128 v[60:63], v14 offset:46592
    ds_read_b128 v[64:67], v14 offset:55296
    ds_read_b128 v[68:71], v14 offset:55808
    ds_read_b128 v[72:75], v14 offset:64512
    ds_read_b128 v[76:79], v14 offset:65024
    v_add_u32 v8, s25, v7
    v_lshlrev_b32 v9, 10, v8
    v_lshl_add_u32 v9, v6, 4, v9
    s_lshl_b32 s21, s18, 7
    v_add_u32 v9, s21, v9
    s_mov_b32 s12, s42
    s_and_b32 s13, s43, 0xffff
    s_mov_b32 s14, 2097152
    s_mov_b32 s15, 0x00020000
    v_lshlrev_b32 v204, 16, v92
    v_and_b32 v205, 0xffff0000, v92
    v_lshlrev_b32 v206, 16, v93
    v_and_b32 v207, 0xffff0000, v93
    v_lshlrev_b32 v208, 16, v94
    v_and_b32 v209, 0xffff0000, v94
    v_lshlrev_b32 v210, 16, v95
    v_and_b32 v211, 0xffff0000, v95
    s_waitcnt lgkmcnt(12)
    v_add_f32 v16, v16, v24
    v_add_f32 v17, v17, v25
    v_add_f32 v18, v18, v26
    v_add_f32 v19, v19, v27
    v_add_f32 v20, v20, v28
    v_add_f32 v21, v21, v29
    v_add_f32 v22, v22, v30
    v_add_f32 v23, v23, v31
    s_waitcnt lgkmcnt(10)
    v_add_f32 v16, v16, v32
    v_add_f32 v17, v17, v33
    v_add_f32 v18, v18, v34
    v_add_f32 v19, v19, v35
    v_add_f32 v20, v20, v36
    v_add_f32 v21, v21, v37
    v_add_f32 v22, v22, v38
    v_add_f32 v23, v23, v39
    s_waitcnt lgkmcnt(8)
    v_add_f32 v16, v16, v40
    v_add_f32 v17, v17, v41
    v_add_f32 v18, v18, v42
    v_add_f32 v19, v19, v43
    v_add_f32 v20, v20, v44
    v_add_f32 v21, v21, v45
    v_add_f32 v22, v22, v46
    v_add_f32 v23, v23, v47
    s_waitcnt lgkmcnt(6)
    v_add_f32 v16, v16, v48
    v_add_f32 v17, v17, v49
    v_add_f32 v18, v18, v50
    v_add_f32 v19, v19, v51
    v_add_f32 v20, v20, v52
    v_add_f32 v21, v21, v53
    v_add_f32 v22, v22, v54
    v_add_f32 v23, v23, v55
    s_waitcnt lgkmcnt(4)
    v_add_f32 v16, v16, v56
    v_add_f32 v17, v17, v57
    v_add_f32 v18, v18, v58
    v_add_f32 v19, v19, v59
    v_add_f32 v20, v20, v60
    v_add_f32 v21, v21, v61
    v_add_f32 v22, v22, v62
    v_add_f32 v23, v23, v63
    s_waitcnt lgkmcnt(2)
    v_add_f32 v16, v16, v64
    v_add_f32 v17, v17, v65
    v_add_f32 v18, v18, v66
    v_add_f32 v19, v19, v67
    v_add_f32 v20, v20, v68
    v_add_f32 v21, v21, v69
    v_add_f32 v22, v22, v70
    v_add_f32 v23, v23, v71
    s_waitcnt lgkmcnt(0)
    v_add_f32 v16, v16, v72
    v_add_f32 v17, v17, v73
    v_add_f32 v18, v18, v74
    v_add_f32 v19, v19, v75
    v_add_f32 v20, v20, v76
    v_add_f32 v21, v21, v77
    v_add_f32 v22, v22, v78
    v_add_f32 v23, v23, v79
    v_add_f32 v16, v16, v204
    v_add_f32 v17, v17, v205
    v_add_f32 v18, v18, v206
    v_add_f32 v19, v19, v207
    v_add_f32 v20, v20, v208
    v_add_f32 v21, v21, v209
    v_add_f32 v22, v22, v210
    v_add_f32 v23, v23, v211
    v_cvt_pk_bf16_f32 v24, v16, v17
    v_cvt_pk_bf16_f32 v25, v18, v19
    v_cvt_pk_bf16_f32 v26, v20, v21
    v_cvt_pk_bf16_f32 v27, v22, v23
    buffer_store_dwordx4 v[24:27], v9, s[12:15], 0 offen sc1
L_oB_73:
    s_waitcnt vmcnt(0)
L_exit_mk:
    s_endpgm
L_slow_mk:
    s_add_u32 s63, s63, 16384
    s_mov_b32 m0, s63
    s_nop 0
    buffer_load_dwordx4 v2, s[12:15], s63 offen offset:0 sc1 lds
    buffer_load_dwordx4 v2, s[12:15], s63 offen offset:1024 sc1 lds
    buffer_load_dwordx4 v2, s[12:15], s63 offen offset:2048 sc1 lds
    buffer_load_dwordx4 v2, s[12:15], s63 offen offset:3072 sc1 lds
    s_add_u32 s63, s63, 16384
    s_mov_b32 m0, s63
    s_nop 0
    buffer_load_dwordx4 v2, s[12:15], s63 offen offset:0 sc1 lds
    buffer_load_dwordx4 v2, s[12:15], s63 offen offset:1024 sc1 lds
    buffer_load_dwordx4 v2, s[12:15], s63 offen offset:2048 sc1 lds
    buffer_load_dwordx4 v2, s[12:15], s63 offen offset:3072 sc1 lds
    s_add_u32 s63, s63, 16384
    s_mov_b32 m0, s63
    s_nop 0
    buffer_load_dwordx4 v2, s[12:15], s63 offen offset:0 sc1 lds
    buffer_load_dwordx4 v2, s[12:15], s63 offen offset:1024 sc1 lds
    buffer_load_dwordx4 v2, s[12:15], s63 offen offset:2048 sc1 lds
    buffer_load_dwordx4 v2, s[12:15], s63 offen offset:3072 sc1 lds
    s_and_b32 s63, s16, 3
    s_lshl_b32 s63, s63, 10
    s_add_u32 s63, s63, 131072
    s_mov_b32 m0, s63
    s_nop 0
    buffer_load_dwordx4 v2, s[12:15], s63 offen sc1 lds
    s_add_u32 m0, s56, 0
    s_nop 0
    buffer_load_dwordx4 v97, s[48:51], s31 offen lds
    s_add_u32 s31, s31, s52
    s_add_u32 m0, s56, 1024
    s_nop 0
    buffer_load_dwordx4 v97, s[48:51], s31 offen lds
    s_add_u32 s31, s31, s52
    s_lshl_b32 s21, s52, 1
    s_cmp_eq_u32 s59, 1
    s_cselect_b32 s21, s21, 0
    s_sub_u32 s31, s31, s21
    s_add_u32 s21, s56, 2048
    s_add_u32 s22, s56, 0
    s_cmp_eq_u32 s59, 1
    s_cselect_b32 m0, s22, s21
    s_nop 0
    buffer_load_dwordx4 v97, s[48:51], s31 offen lds
    s_add_u32 s31, s31, s52
    s_add_u32 s21, s56, 3072
    s_add_u32 s22, s56, 1024
    s_cmp_eq_u32 s59, 1
    s_cselect_b32 m0, s22, s21
    s_nop 0
    buffer_load_dwordx4 v97, s[48:51], s31 offen lds
    s_add_u32 s31, s31, s52
    s_waitcnt vmcnt(0)
    s_barrier
    s_cmp_eq_u32 s59, 1
    s_cbranch_scc1 L_pb_74
    ds_read_b64_tr_b16 v[104:105], v98 offset:0
    ds_read_b64_tr_b16 v[106:107], v98 offset:512
    ds_read_b64_tr_b16 v[108:109], v98 offset:32
    ds_read_b64_tr_b16 v[110:111], v98 offset:544
    ds_read_b64_tr_b16 v[112:113], v98 offset:64
    ds_read_b64_tr_b16 v[114:115], v98 offset:576
    ds_read_b64_tr_b16 v[116:117], v98 offset:96
    ds_read_b64_tr_b16 v[118:119], v98 offset:608
    v_mov_b32 v100, 0x3f803f80
    v_mov_b32 v101, 0x3f803f80
    v_mov_b32 v102, 0x3f803f80
    v_mov_b32 v103, 0x3f803f80
    s_waitcnt lgkmcnt(0)
    buffer_store_dwordx4 v[104:107], v2, s[8:11], s57 offen sc1
    v_mfma_f32_16x16x32_bf16 v[120:123], v[104:107], v[100:103], 0
    s_add_u32 s57, s57, 16384
    buffer_store_dwordx4 v[108:111], v2, s[8:11], s57 offen sc1
    v_mfma_f32_16x16x32_bf16 v[124:127], v[108:111], v[100:103], 0
    s_add_u32 s57, s57, 16384
    buffer_store_dwordx4 v[112:115], v2, s[8:11], s57 offen sc1
    v_mfma_f32_16x16x32_bf16 v[128:131], v[112:115], v[100:103], 0
    s_add_u32 s57, s57, 16384
    buffer_store_dwordx4 v[116:119], v2, s[8:11], s57 offen sc1
    v_mfma_f32_16x16x32_bf16 v[132:135], v[116:119], v[100:103], 0
    s_add_u32 s57, s57, 16384
    v_lshrrev_b32 v96, 4, v1
    v_lshlrev_b32 v96, 4, v96
    s_mov_b32 exec_lo, 0x00010001
    s_mov_b32 exec_hi, 0x00010001
    s_nop 4
    buffer_store_dwordx4 v[120:123], v96, s[8:11], s58 offen offset:0 sc1
    buffer_store_dwordx4 v[124:127], v96, s[8:11], s58 offen offset:1024 sc1
    buffer_store_dwordx4 v[128:131], v96, s[8:11], s58 offen offset:2048 sc1
    buffer_store_dwordx4 v[132:135], v96, s[8:11], s58 offen offset:3072 sc1
    s_mov_b64 exec, -1
    s_branch L_pe_75
L_pb_74:
    ds_read_b64_tr_b16 v[104:105], v98 offset:0
    ds_read_b64_tr_b16 v[106:107], v99 offset:0
    ds_read_b64_tr_b16 v[108:109], v98 offset:64
    ds_read_b64_tr_b16 v[110:111], v99 offset:64
    s_waitcnt lgkmcnt(0)
    buffer_store_dwordx4 v[104:107], v2, s[8:11], s57 offen sc1
    s_add_u32 s57, s57, s58
    buffer_store_dwordx4 v[108:111], v2, s[8:11], s57 offen sc1
    s_add_u32 s57, s57, s58
L_pe_75:
    s_waitcnt vmcnt(0)
    s_barrier
    s_cmp_lg_u32 s16, 0
    s_cbranch_scc1 L_w0_76
    v_mov_b32 v89, s62
    v_mov_b32 v91, 0
    s_lshl_b32 s21, s19, 7
    s_add_u32 s21, s21, 25362432
    s_mov_b64 exec, 1
    buffer_store_dword v89, v91, s[8:11], s21 offen sc1
    s_mov_b64 exec, -1
L_w0_76:
    s_cmp_lg_u32 s16, 7
    s_cbranch_scc1 L_w0_77
    s_mov_b32 s22, 0
L_pp_78:
    v_lshlrev_b32 v89, 7, v1
    s_mov_b32 s21, 25362432
    s_add_u32 s23, s21, 0
    buffer_load_dword v92, v89, s[8:11], s23 offen sc1
    s_add_u32 s23, s21, 8192
    buffer_load_dword v93, v89, s[8:11], s23 offen sc1
    s_add_u32 s23, s21, 16384
    buffer_load_dword v94, v89, s[8:11], s23 offen sc1
    s_add_u32 s23, s21, 24576
    buffer_load_dword v95, v89, s[8:11], s23 offen sc1
    s_add_u32 s22, s22, 1
    s_waitcnt vmcnt(0)
    v_xor_b32 v92, s62, v92
    v_xor_b32 v93, s62, v93
    v_xor_b32 v94, s62, v94
    v_xor_b32 v95, s62, v95
    v_or3_b32 v92, v92, v93, v94
    v_or_b32 v92, v92, v95
    v_cmp_ne_u32 vcc, 0, v92
    s_cmp_gt_u32 s22, 200000
    s_cbranch_scc1 L_pd_79
    s_cbranch_vccnz L_pp_78
L_pd_79:
L_w0_77:
    s_barrier
    v_add_u32 v3, s55, v2
    v_mov_b32 v112, 0xff800000
    s_mov_b32 s21, 32
L_s1_80:
    ds_read_b128 v[8:11], v3
    v_add_u32 v3, 2112, v3
    s_waitcnt lgkmcnt(0)
    v_mfma_f32_32x32x16_bf16 v[40:55], v[8:11], v[4:7], 0
    s_nop 15
    s_nop 3
    v_max3_f32 v112, v112, v40, v41
    v_max3_f32 v112, v112, v42, v43
    v_max3_f32 v112, v112, v44, v45
    v_max3_f32 v112, v112, v46, v47
    v_max3_f32 v112, v112, v48, v49
    v_max3_f32 v112, v112, v50, v51
    v_max3_f32 v112, v112, v52, v53
    v_max3_f32 v112, v112, v54, v55
    s_sub_u32 s21, s21, 1
    s_cmp_lg_u32 s21, 0
    s_cbranch_scc1 L_s1_80
    v_mov_b32 v113, v112
    s_nop 1
    v_permlane32_swap_b32 v112, v113
    s_nop 1
    v_max_f32 v112, v112, v113
    s_mul_i32 s21, s16, 3072
    s_add_u32 s21, s21, 139264
    v_lshlrev_b32 v114, 2, v1
    v_add_u32 v115, s21, v114
    ds_write_b32 v115, v112
    s_xor_b32 s22, s16, 4
    s_mul_i32 s22, s22, 3072
    s_add_u32 s22, s22, 139264
    v_add_u32 v115, s22, v114
    s_waitcnt lgkmcnt(0)
    s_barrier
    ds_read_b32 v113, v115
    s_waitcnt lgkmcnt(0)
    v_max_f32 v112, v112, v113
    s_barrier
    v_sub_f32 v96, 0, v112
    v_sub_f32 v97, 0, v112
    v_sub_f32 v98, 0, v112
    v_sub_f32 v99, 0, v112
    v_sub_f32 v100, 0, v112
    v_sub_f32 v101, 0, v112
    v_sub_f32 v102, 0, v112
    v_sub_f32 v103, 0, v112
    v_sub_f32 v104, 0, v112
    v_sub_f32 v105, 0, v112
    v_sub_f32 v106, 0, v112
    v_sub_f32 v107, 0, v112
    v_sub_f32 v108, 0, v112
    v_sub_f32 v109, 0, v112
    v_sub_f32 v110, 0, v112
    v_sub_f32 v111, 0, v112
    v_mov_b32 v72, 0
    v_mov_b32 v73, 0
    v_mov_b32 v74, 0
    v_mov_b32 v75, 0
    v_mov_b32 v76, 0
    v_mov_b32 v77, 0
    v_mov_b32 v78, 0
    v_mov_b32 v79, 0
    v_mov_b32 v80, 0
    v_mov_b32 v81, 0
    v_mov_b32 v82, 0
    v_mov_b32 v83, 0
    v_mov_b32 v84, 0
    v_mov_b32 v85, 0
    v_mov_b32 v86, 0
    v_mov_b32 v87, 0
    v_add_u32 v3, s55, v2
    v_add_u32 v88, s55, v90
    s_mov_b32 s21, 32
L_s2_81:
    ds_read_b128 v[8:11], v3
    ds_read_b128 v[16:19], v88
    ds_read_b128 v[20:23], v88 offset:544
    v_add_u32 v3, 2112, v3
    v_add_u32 v88, 2112, v88
    s_waitcnt lgkmcnt(0)
    v_mfma_f32_32x32x16_bf16 v[40:55], v[8:11], v[4:7], v[96:111]
    s_nop 15
    s_nop 3
    v_exp_f32 v40, v40
    v_exp_f32 v41, v41
    v_exp_f32 v42, v42
    v_exp_f32 v43, v43
    v_exp_f32 v44, v44
    v_exp_f32 v45, v45
    v_exp_f32 v46, v46
    v_exp_f32 v47, v47
    v_exp_f32 v48, v48
    v_exp_f32 v49, v49
    v_exp_f32 v50, v50
    v_exp_f32 v51, v51
    v_exp_f32 v52, v52
    v_exp_f32 v53, v53
    v_exp_f32 v54, v54
    v_exp_f32 v55, v55
    s_nop 0
    v_cvt_pk_bf16_f32 v32, v40, v41
    v_cvt_pk_bf16_f32 v33, v42, v43
    v_cvt_pk_bf16_f32 v34, v44, v45
    v_cvt_pk_bf16_f32 v35, v46, v47
    v_cvt_pk_bf16_f32 v36, v48, v49
    v_cvt_pk_bf16_f32 v37, v50, v51
    v_cvt_pk_bf16_f32 v38, v52, v53
    v_cvt_pk_bf16_f32 v39, v54, v55
    s_nop 1
    v_mfma_f32_32x32x16_bf16 v[72:87], v[16:19], v[32:35], v[72:87]
    v_mfma_f32_32x32x16_bf16 v[72:87], v[20:23], v[36:39], v[72:87]
    s_sub_u32 s21, s21, 1
    s_cmp_lg_u32 s21, 0
    s_cbranch_scc1 L_s2_81
    s_nop 15
    s_mul_i32 s21, s16, 3072
    s_add_u32 s21, s21, 139264
    v_add_u32 v56, s21, v2
    s_xor_b32 s22, s16, 4
    s_mul_i32 s22, s22, 3072
    s_add_u32 s22, s22, 139264
    v_add_u32 v57, s22, v2
    s_nop 7
    s_cmp_ge_u32 s16, 4
    s_cbranch_scc0 L_xw_82
    ds_write_b128 v56, v[72:75] offset:0
    ds_write_b128 v56, v[76:79] offset:1024
    ds_write_b128 v56, v[80:83] offset:2048
L_xw_82:
    s_waitcnt lgkmcnt(0)
    s_barrier
    s_cmp_ge_u32 s16, 4
    s_cbranch_scc1 L_fa_83
    ds_read_b128 v[44:47], v57 offset:0
    ds_read_b128 v[48:51], v57 offset:1024
    ds_read_b128 v[52:55], v57 offset:2048
    s_waitcnt lgkmcnt(0)
    v_add_f32 v72, v72, v44
    v_add_f32 v73, v73, v45
    v_add_f32 v74, v74, v46
    v_add_f32 v75, v75, v47
    v_add_f32 v76, v76, v48
    v_add_f32 v77, v77, v49
    v_add_f32 v78, v78, v50
    v_add_f32 v79, v79, v51
    v_add_f32 v80, v80, v52
    v_rcp_f32 v80, v80
    s_nop 0
    v_mul_f32 v72, v72, v80
    v_mul_f32 v73, v73, v80
    v_mul_f32 v74, v74, v80
    v_mul_f32 v75, v75, v80
    v_mul_f32 v76, v76, v80
    v_mul_f32 v77, v77, v80
    v_mul_f32 v78, v78, v80
    v_mul_f32 v79, v79, v80
    v_cvt_pk_bf16_f32 v40, v72, v73
    v_cvt_pk_bf16_f32 v41, v74, v75
    v_cvt_pk_bf16_f32 v42, v76, v77
    v_cvt_pk_bf16_f32 v43, v78, v79
    s_add_u32 s21, s20, 0
    buffer_store_dwordx4 v[40:43], v2, s[8:11], s21 offen sc1
L_fa_83:
    s_waitcnt vmcnt(0)
    s_barrier
    s_cmp_lg_u32 s16, 0
    s_cbranch_scc1 L_w0_84
    v_mov_b32 v89, s62
    v_mov_b32 v91, 0
    s_lshl_b32 s21, s19, 7
    s_add_u32 s21, s21, 25165824
    s_mov_b64 exec, 1
    buffer_store_dword v89, v91, s[8:11], s21 offen sc1
    s_mov_b64 exec, -1
L_w0_84:
    v_mov_b32 v4, v252
    v_mov_b32 v5, v253
    v_mov_b32 v6, v254
    v_mov_b32 v7, v255
    v_add_u32 v3, s55, v2
    v_mov_b32 v112, 0xff800000
    s_mov_b32 s21, 32
L_s1_85:
    ds_read_b128 v[8:11], v3
    v_add_u32 v3, 2112, v3
    s_waitcnt lgkmcnt(0)
    v_mfma_f32_32x32x16_bf16 v[40:55], v[8:11], v[4:7], 0
    s_nop 15
    s_nop 3
    v_max3_f32 v112, v112, v40, v41
    v_max3_f32 v112, v112, v42, v43
    v_max3_f32 v112, v112, v44, v45
    v_max3_f32 v112, v112, v46, v47
    v_max3_f32 v112, v112, v48, v49
    v_max3_f32 v112, v112, v50, v51
    v_max3_f32 v112, v112, v52, v53
    v_max3_f32 v112, v112, v54, v55
    s_sub_u32 s21, s21, 1
    s_cmp_lg_u32 s21, 0
    s_cbranch_scc1 L_s1_85
    v_mov_b32 v113, v112
    s_nop 1
    v_permlane32_swap_b32 v112, v113
    s_nop 1
    v_max_f32 v112, v112, v113
    s_mul_i32 s21, s16, 3072
    s_add_u32 s21, s21, 139264
    v_lshlrev_b32 v114, 2, v1
    v_add_u32 v115, s21, v114
    ds_write_b32 v115, v112
    s_xor_b32 s22, s16, 4
    s_mul_i32 s22, s22, 3072
    s_add_u32 s22, s22, 139264
    v_add_u32 v115, s22, v114
    s_waitcnt lgkmcnt(0)
    s_barrier
    ds_read_b32 v113, v115
    s_waitcnt lgkmcnt(0)
    v_max_f32 v112, v112, v113
    s_barrier
    v_sub_f32 v96, 0, v112
    v_sub_f32 v97, 0, v112
    v_sub_f32 v98, 0, v112
    v_sub_f32 v99, 0, v112
    v_sub_f32 v100, 0, v112
    v_sub_f32 v101, 0, v112
    v_sub_f32 v102, 0, v112
    v_sub_f32 v103, 0, v112
    v_sub_f32 v104, 0, v112
    v_sub_f32 v105, 0, v112
    v_sub_f32 v106, 0, v112
    v_sub_f32 v107, 0, v112
    v_sub_f32 v108, 0, v112
    v_sub_f32 v109, 0, v112
    v_sub_f32 v110, 0, v112
    v_sub_f32 v111, 0, v112
    v_mov_b32 v72, 0
    v_mov_b32 v73, 0
    v_mov_b32 v74, 0
    v_mov_b32 v75, 0
    v_mov_b32 v76, 0
    v_mov_b32 v77, 0
    v_mov_b32 v78, 0
    v_mov_b32 v79, 0
    v_mov_b32 v80, 0
    v_mov_b32 v81, 0
    v_mov_b32 v82, 0
    v_mov_b32 v83, 0
    v_mov_b32 v84, 0
    v_mov_b32 v85, 0
    v_mov_b32 v86, 0
    v_mov_b32 v87, 0
    v_add_u32 v3, s55, v2
    v_add_u32 v88, s55, v90
    s_mov_b32 s21, 32
L_s2_86:
    ds_read_b128 v[8:11], v3
    ds_read_b128 v[16:19], v88
    ds_read_b128 v[20:23], v88 offset:544
    v_add_u32 v3, 2112, v3
    v_add_u32 v88, 2112, v88
    s_waitcnt lgkmcnt(0)
    v_mfma_f32_32x32x16_bf16 v[40:55], v[8:11], v[4:7], v[96:111]
    s_nop 15
    s_nop 3
    v_exp_f32 v40, v40
    v_exp_f32 v41, v41
    v_exp_f32 v42, v42
    v_exp_f32 v43, v43
    v_exp_f32 v44, v44
    v_exp_f32 v45, v45
    v_exp_f32 v46, v46
    v_exp_f32 v47, v47
    v_exp_f32 v48, v48
    v_exp_f32 v49, v49
    v_exp_f32 v50, v50
    v_exp_f32 v51, v51
    v_exp_f32 v52, v52
    v_exp_f32 v53, v53
    v_exp_f32 v54, v54
    v_exp_f32 v55, v55
    s_nop 0
    v_cvt_pk_bf16_f32 v32, v40, v41
    v_cvt_pk_bf16_f32 v33, v42, v43
    v_cvt_pk_bf16_f32 v34, v44, v45
    v_cvt_pk_bf16_f32 v35, v46, v47
    v_cvt_pk_bf16_f32 v36, v48, v49
    v_cvt_pk_bf16_f32 v37, v50, v51
    v_cvt_pk_bf16_f32 v38, v52, v53
    v_cvt_pk_bf16_f32 v39, v54, v55
    s_nop 1
    v_mfma_f32_32x32x16_bf16 v[72:87], v[16:19], v[32:35], v[72:87]
    v_mfma_f32_32x32x16_bf16 v[72:87], v[20:23], v[36:39], v[72:87]
    s_sub_u32 s21, s21, 1
    s_cmp_lg_u32 s21, 0
    s_cbranch_scc1 L_s2_86
    s_nop 15
    buffer_load_dwordx4 v[96:99], v2, s[8:11], s34 offen offset:0 sc1
    buffer_load_dwordx4 v[100:103], v2, s[8:11], s35 offen offset:0 sc1
    buffer_load_dwordx4 v[104:107], v2, s[8:11], s34 offen offset:1024 sc1
    buffer_load_dwordx4 v[108:111], v2, s[8:11], s35 offen offset:1024 sc1
    buffer_load_dwordx4 v[112:115], v2, s[8:11], s34 offen offset:2048 sc1
    buffer_load_dwordx4 v[116:119], v2, s[8:11], s35 offen offset:2048 sc1
    buffer_load_dwordx4 v[120:123], v2, s[8:11], s34 offen offset:3072 sc1
    s_add_u32 s34, s34, 4096
    buffer_load_dwordx4 v[124:127], v2, s[8:11], s35 offen offset:3072 sc1
    s_add_u32 s35, s35, 4096
    buffer_load_dwordx4 v[128:131], v2, s[8:11], s34 offen offset:0 sc1
    buffer_load_dwordx4 v[132:135], v2, s[8:11], s35 offen offset:0 sc1
    buffer_load_dwordx4 v[136:139], v2, s[8:11], s34 offen offset:1024 sc1
    buffer_load_dwordx4 v[140:143], v2, s[8:11], s35 offen offset:1024 sc1
    buffer_load_dwordx4 v[144:147], v2, s[8:11], s34 offen offset:2048 sc1
    buffer_load_dwordx4 v[148:151], v2, s[8:11], s35 offen offset:2048 sc1
    buffer_load_dwordx4 v[152:155], v2, s[8:11], s34 offen offset:3072 sc1
    s_add_u32 s34, s34, 4096
    buffer_load_dwordx4 v[156:159], v2, s[8:11], s35 offen offset:3072 sc1
    s_add_u32 s35, s35, 4096
    buffer_load_dwordx4 v[160:163], v2, s[8:11], s34 offen offset:0 sc1
    buffer_load_dwordx4 v[164:167], v2, s[8:11], s35 offen offset:0 sc1
    buffer_load_dwordx4 v[168:171], v2, s[8:11], s34 offen offset:1024 sc1
    buffer_load_dwordx4 v[172:175], v2, s[8:11], s35 offen offset:1024 sc1
    buffer_load_dwordx4 v[176:179], v2, s[8:11], s34 offen offset:2048 sc1
    buffer_load_dwordx4 v[180:183], v2, s[8:11], s35 offen offset:2048 sc1
    buffer_load_dwordx4 v[184:187], v2, s[8:11], s34 offen offset:3072 sc1
    s_add_u32 s34, s34, 4096
    buffer_load_dwordx4 v[188:191], v2, s[8:11], s35 offen offset:3072 sc1
    s_add_u32 s35, s35, 4096
    buffer_load_dwordx4 v[192:195], v2, s[8:11], s34 offen offset:0 sc1
    buffer_load_dwordx4 v[196:199], v2, s[8:11], s35 offen offset:0 sc1
    buffer_load_dwordx4 v[200:203], v2, s[8:11], s34 offen offset:1024 sc1
    buffer_load_dwordx4 v[204:207], v2, s[8:11], s35 offen offset:1024 sc1
    buffer_load_dwordx4 v[208:211], v2, s[8:11], s34 offen offset:2048 sc1
    buffer_load_dwordx4 v[212:215], v2, s[8:11], s35 offen offset:2048 sc1
    buffer_load_dwordx4 v[216:219], v2, s[8:11], s34 offen offset:3072 sc1
    s_add_u32 s34, s34, 4096
    buffer_load_dwordx4 v[220:223], v2, s[8:11], s35 offen offset:3072 sc1
    s_add_u32 s35, s35, 4096
    buffer_load_dwordx4 v[224:227], v2, s[8:11], s30 offen offset:0 sc1
    buffer_load_dwordx4 v[228:231], v2, s[8:11], s30 offen offset:1024 sc1
    buffer_load_dwordx4 v[232:235], v2, s[8:11], s30 offen offset:2048 sc1
    buffer_load_dwordx4 v[236:239], v2, s[8:11], s30 offen offset:3072 sc1
    s_add_u32 s30, s30, 32768
    buffer_load_dwordx4 v[240:243], v2, s[8:11], s30 offen offset:0 sc1
    buffer_load_dwordx4 v[244:247], v2, s[8:11], s30 offen offset:1024 sc1
    buffer_load_dwordx4 v[248:251], v2, s[8:11], s30 offen offset:2048 sc1
    buffer_load_dwordx4 v[252:255], v2, s[8:11], s30 offen offset:3072 sc1
    v_lshrrev_b32 v92, 3, v1
    v_and_b32 v93, 7, v1
    s_lshl_b32 s25, s17, 6
    s_lshl_b32 s21, s16, 3
    s_add_u32 s25, s25, s21
    v_add_u32 v93, s25, v93
    v_lshlrev_b32 v93, 10, v93
    v_lshl_add_u32 v93, v92, 4, v93
    s_lshl_b32 s21, s18, 7
    v_add_u32 v93, s21, v93
    s_mov_b32 s12, s6
    s_and_b32 s13, s7, 0xffff
    s_mov_b32 s14, 2097152
    s_mov_b32 s15, 0x00020000
    buffer_load_dwordx4 v[92:95], v93, s[12:15], 0 offen
    s_lshl_b32 s21, s17, 3
    s_add_u32 s21, s21, s16
    s_lshl_b32 s21, s21, 7
    s_add_u32 s38, s21, 25165824
    v_mov_b32 v91, 0
    buffer_load_dword v89, v91, s[8:11], s38 offen sc1
    s_branch L_join_mk
.section .rodata,"a"
.p2align 6
.amdhsa_kernel sequential_preLN__grouped_kv_mqa__glu_gated_reglu__prompt_kernel
  .amdhsa_next_free_vgpr 256
  .amdhsa_next_free_sgpr 102
  .amdhsa_accum_offset 256
  .amdhsa_group_segment_fixed_size 0
  .amdhsa_kernarg_size 96
  .amdhsa_user_sgpr_count 2
  .amdhsa_user_sgpr_kernarg_segment_ptr 1
  .amdhsa_system_sgpr_workgroup_id_x 1
  .amdhsa_float_denorm_mode_32 3
.end_amdhsa_kernel
```
